```python
import torch

def _softmax(x, axis=-1):
    return torch.softmax(x, dim=axis)
def _gelu(x):
    return torch.nn.functional.gelu(x, approximate="tanh")
def _silu(x):
    return torch.nn.functional.silu(x)
def _sigmoid(x):
    return torch.sigmoid(x)
def _layernorm(x, axis=-1, eps=1e-5):
    m = x.mean(dim=axis, keepdim=True)
    v = x.var(dim=axis, keepdim=True, unbiased=False)
    return (x - m) / torch.sqrt(v + eps)
def _scatter_add(tgt, idx, src, axis=0):
    return tgt.clone().index_add_(axis, idx, src)
def _segment_sum(src, seg, n):
    out = torch.zeros((n,) + src.shape[1:], dtype=src.dtype)
    return out.index_add_(0, seg, src)
def _pad(x, pw):
    flat = tuple(v for pair in reversed(pw) for v in pair)
    return torch.nn.functional.pad(x, flat)

kernel_name = 'parallel_sum__gqa_block_cached__geglu_ffn__decode'

def setup_inputs():

    _w = (lambda a: (lambda t: t.to(torch.bfloat16) if t.is_floating_point() else t)(torch.as_tensor(a)))
    def _A_setup():
        B, Sq, D = 4, 1, 640
        Hq, Hkv, Sk, Dh = 32, 32, 4096, 128
        assert Hq % Hkv == 0, (Hq, Hkv)
        return {
            "x": _w((lambda *s: torch.randn(*s, dtype=torch.bfloat16) * 0.05)(B, Sq, D)),
            "k_cache": _w((lambda *s: torch.randn(*s, dtype=torch.bfloat16) * 3.2)(B, Hkv, Sk, Dh)),
            "v_cache": _w((lambda *s: torch.randn(*s, dtype=torch.bfloat16) * 1.6)(B, Hkv, Sk, Dh)),
            "wq": _w((lambda *s: torch.randn(*s, dtype=torch.bfloat16) * 3.2)(D, Hq * Dh) * (D ** -0.5)),
            "wo": _w((lambda *s: torch.randn(*s, dtype=torch.bfloat16) * 1.6)(Hq * Dh, D) * ((Hq * Dh) ** -0.5)),
        }
    _A_in = _A_setup()

    def _B_setup():
        B, S, D, F = 4, 1, 640, 1728
        return {
            "x": _w((lambda *s: torch.randn(*s, dtype=torch.bfloat16) * 0.05)(B, S, D)),
            "w_gate": _w((lambda *s: torch.randn(*s, dtype=torch.bfloat16) * 0.05)(D, F)),
            "w_up": _w((lambda *s: torch.randn(*s, dtype=torch.bfloat16) * 0.05)(D, F)),
            "w_down": _w((lambda *s: torch.randn(*s, dtype=torch.bfloat16) * 0.05)(F, D)),
        }
    _B_in = _B_setup()

    return {
        "A_x": _A_in["x"],
        "A_k_cache": _A_in["k_cache"],
        "A_v_cache": _A_in["v_cache"],
        "A_wq": _A_in["wq"],
        "A_wo": _A_in["wo"],
        "B_x": _B_in["x"],
        "B_w_gate": _B_in["w_gate"],
        "B_w_up": _B_in["w_up"],
        "B_w_down": _B_in["w_down"],
    }

def reference(A_x, A_k_cache, A_v_cache, A_wq, A_wo, B_x, B_w_gate, B_w_up, B_w_down):
    def _A_ref(x, k_cache, v_cache, wq, wo):
        B, Sq, D = x.shape
        Hq, Dh = 32, 128
        Hkv = k_cache.shape[1]
        rep = Hq // Hkv
        q = (lambda x, *d: x.permute(*d))((x @ wq).reshape(B, Sq, Hq, Dh), 0, 2, 1, 3)
        k = (lambda x, n, axis: torch.repeat_interleave(x, n, dim=axis))(k_cache, rep, axis=1)
        v = (lambda x, n, axis: torch.repeat_interleave(x, n, dim=axis))(v_cache, rep, axis=1)
        scores = torch.einsum("bhqd,bhkd->bhqk", q, k) * (Dh ** -0.5)
        p = _softmax(scores, axis=-1)
        o = torch.einsum("bhqk,bhkd->bhqd", p, v)
        return (lambda x, *d: x.permute(*d))(o, 0, 2, 1, 3).reshape(B, Sq, Hq * Dh) @ wo

    def _B_ref(x, w_gate, w_up, w_down):
        return (_gelu(x @ w_gate) * (x @ w_up)) @ w_down

    x = A_x
    xn = _layernorm(x, axis=-1)
    return x + _A_ref(xn, A_k_cache, A_v_cache, A_wq, A_wo) + _B_ref(xn, B_w_gate, B_w_up, B_w_down)
```

```asm
; @launch grid=(256,1,1) block=(256,1,1) lds=51200
.amdgcn_target "amdgcn-amd-amdhsa--gfx950"
.text
.globl parallel_sum__gqa_block_cached__geglu_ffn__decode_kernel
.p2align 8
.type parallel_sum__gqa_block_cached__geglu_ffn__decode_kernel,@function
parallel_sum__gqa_block_cached__geglu_ffn__decode_kernel:
  s_cmp_ge_u32 s2, 256
  s_cbranch_scc1 L_end
  s_load_dwordx16 s[4:19], s[0:1], 0
  s_load_dwordx8 s[20:27], s[0:1], 64
  v_and_b32 v1, 63, v0
  v_lshrrev_b32 v16, 6, v0
  s_mov_b32 s91, s2
  v_readfirstlane_b32 s72, v16
  s_and_b32 s73, s2, 7
  s_lshl_b32 s73, s73, 2
  s_bfe_u32 s74, s2, 0x20004
  s_or_b32 s73, s73, s74
  s_bfe_u32 s74, s2, 0x10003
  s_lshr_b32 s75, s2, 6
  s_lshl_b32 s3, s75, 1
  s_or_b32 s3, s3, s74
  s_lshl_b32 s78, s75, 5
  s_add_u32 s76, s78, s73
  v_and_b32 v2, 15, v1
  v_lshrrev_b32 v3, 4, v1
  v_lshlrev_b32 v17, 4, v1
  v_lshlrev_b32 v18, 4, v2
  s_lshl_b32 s78, s76, 20
  s_lshl_b32 s79, s74, 19
  s_add_u32 s78, s78, s79
  s_lshl_b32 s79, s72, 10
  v_add_u32 v4, s79, v17
  v_lshl_add_u32 v5, v3, 13, v18
  v_lshlrev_b32 v24, 2, v1
  s_mul_i32 s80, s3, 80
  s_mul_i32 s81, s72, 20
  s_add_u32 s93, s80, s81
  s_lshl_b32 s80, s93, 13
  s_lshl_b32 s81, s73, 8
  s_add_u32 s80, s80, s81
  s_mul_i32 s79, s72, 1280
  s_waitcnt lgkmcnt(0)
  s_mov_b32 s90, 2596864
  s_load_dwordx2 s[68:69], s[26:27], s90
  s_mov_b32 s60, s4
  s_mov_b32 s61, s5
  s_mov_b32 s62, 5120
  s_mov_b32 s63, 0x20000
  buffer_load_dword v26, v24, s[60:63], s79 offen offset:0
  buffer_load_dword v27, v24, s[60:63], s79 offen offset:256
  buffer_load_dword v28, v24, s[60:63], s79 offen offset:512
  buffer_load_dword v29, v24, s[60:63], s79 offen offset:768
  buffer_load_dword v30, v24, s[60:63], s79 offen offset:1024
  s_mov_b32 s40, s10
  s_mov_b32 s41, s11
  s_mov_b32 s42, 5242880
  s_mov_b32 s43, 0x20000
  buffer_load_dwordx4 a[0:3], v5, s[40:43], s80 offen
  s_add_u32 s80, s80, 32768
  buffer_load_dwordx4 a[4:7], v5, s[40:43], s80 offen
  s_add_u32 s80, s80, 32768
  buffer_load_dwordx4 a[8:11], v5, s[40:43], s80 offen
  s_add_u32 s80, s80, 32768
  buffer_load_dwordx4 a[12:15], v5, s[40:43], s80 offen
  s_add_u32 s80, s80, 32768
  buffer_load_dwordx4 a[16:19], v5, s[40:43], s80 offen
  s_add_u32 s36, s6, s78
  s_addc_u32 s37, s7, 0
  s_mov_b32 s38, 524288
  s_mov_b32 s39, 0x20000
  s_mov_b32 s77, 0
  buffer_load_dwordx4 v[128:131], v4, s[36:39], s77 offen nt
  s_add_u32 s77, s77, 4096
  buffer_load_dwordx4 v[132:135], v4, s[36:39], s77 offen nt
  s_add_u32 s77, s77, 4096
  s_add_u32 s32, s8, s78
  s_addc_u32 s33, s9, 0
  s_mov_b32 s34, 524288
  s_mov_b32 s35, 0x20000
  s_mov_b32 s56, s26
  s_mov_b32 s57, s27
  s_mov_b32 s58, 2597120
  s_mov_b32 s59, 0x20000
  s_mov_b32 s44, s12
  s_mov_b32 s45, s13
  s_mov_b32 s46, 5242880
  s_mov_b32 s47, 0x20000
  s_mov_b32 s52, s20
  s_mov_b32 s53, s21
  s_mov_b32 s54, 2211840
  s_mov_b32 s55, 0x20000
  s_mov_b32 s64, s22
  s_mov_b32 s65, s23
  s_mov_b32 s66, 5120
  s_mov_b32 s67, 0x20000
  s_and_b32 s79, s91, 7
  s_lshr_b32 s81, s91, 3
  s_mov_b32 s96, 0
  s_mov_b32 s95, 0
  s_cmp_eq_u32 s79, 0
  s_cselect_b32 s96, 28, s96
  s_cselect_b32 s95, 0, s95
  s_cmp_eq_u32 s79, 2
  s_cselect_b32 s96, 31, s96
  s_cselect_b32 s95, 28, s95
  s_cmp_eq_u32 s79, 4
  s_cselect_b32 s96, 28, s96
  s_cselect_b32 s95, 59, s95
  s_cmp_eq_u32 s79, 6
  s_cselect_b32 s96, 21, s96
  s_cselect_b32 s95, 87, s95
  s_add_u32 s95, s95, s81
  s_cmp_lt_u32 s81, s96
  s_cselect_b32 s96, 1, 0
  s_bitcmp1_b32 s95, 1
  s_cselect_b32 s48, s18, s16
  s_cselect_b32 s49, s19, s17
  s_mov_b32 s50, 2211840
  s_mov_b32 s51, 0x20000
  v_mul_u32_u24 v6, 1280, v3
  v_add_u32 v6, v6, v18
  v_bfe_u32 v32, v1, 3, 1
  v_lshl_add_u32 v32, v3, 1, v32
  v_mul_u32_u24 v7, 3456, v32
  v_and_b32 v33, 7, v1
  v_lshl_add_u32 v7, v33, 4, v7
  s_and_b32 s79, s95, 1
  s_mul_i32 s79, s79, 320
  s_mul_i32 s81, s72, 80
  s_add_u32 s97, s79, s81
  s_mul_i32 s79, s97, 3456
  s_lshr_b32 s94, s95, 2
  s_lshl_b32 s81, s94, 7
  s_add_u32 s78, s79, s81
  v_and_b32 v32, 1, v1
  v_cmp_eq_u32 vcc, 1, v32
  v_mov_b32 v33, 0xffff
  v_mov_b32 v34, 0xffff0000
  v_cndmask_b32 v33, v33, v34, vcc
  v_bfe_u32 v32, v1, 1, 2
  v_cmp_eq_u32 vcc, 0, v32
  s_nop 1
  v_cndmask_b32 v96, 0, v33, vcc
  v_cmp_eq_u32 vcc, 1, v32
  s_nop 1
  v_cndmask_b32 v97, 0, v33, vcc
  v_cmp_eq_u32 vcc, 2, v32
  s_nop 1
  v_cndmask_b32 v98, 0, v33, vcc
  v_cmp_eq_u32 vcc, 3, v32
  s_nop 1
  v_cndmask_b32 v99, 0, v33, vcc
  s_mov_b32 s84, 0xcccccccc
  s_mov_b32 s85, 0xcccccccc
  s_mov_b32 s86, 0xaaaaaaaa
  s_mov_b32 s87, 0xaaaaaaaa
  s_mov_b32 s88, 0x00ff00ff
  s_mov_b32 s89, 0xff00ff00
  v_and_b32 v66, 1, v1
  v_mul_u32_u24 v66, 320, v66
  v_lshrrev_b32 v32, 1, v1
  v_add_lshl_u32 v66, v66, v32, 2
  s_mul_i32 s79, s72, 2560
  v_add_u32 v66, s79, v66
  v_bfe_u32 v67, v1, 3, 1
  v_mul_u32_u24 v67, 2560, v67
  v_mul_u32_u24 v32, 640, v3
  v_add3_u32 v67, v67, v32, s93
  v_bfe_u32 v32, v1, 3, 1
  v_lshl_add_u32 v32, v3, 1, v32
  v_and_b32 v32, 3, v32
  v_mul_u32_u24 v68, 160, v32
  v_lshrrev_b32 v32, 1, v3
  v_add_u32 v68, v68, v32
  v_lshlrev_b32 v68, 2, v68
  v_add_u32 v68, s97, v68
  s_waitcnt vmcnt(7)
  v_lshlrev_b32 v36, 16, v26
  v_and_b32 v37, 0xffff0000, v26
  v_lshlrev_b32 v38, 16, v27
  v_and_b32 v39, 0xffff0000, v27
  v_lshlrev_b32 v40, 16, v28
  v_and_b32 v41, 0xffff0000, v28
  v_lshlrev_b32 v42, 16, v29
  v_and_b32 v43, 0xffff0000, v29
  v_lshlrev_b32 v44, 16, v30
  v_and_b32 v45, 0xffff0000, v30
  v_readfirstlane_b32 s79, v36
  buffer_load_dwordx4 v[136:139], v4, s[36:39], s77 offen nt
  s_add_u32 s77, s77, 4096
  buffer_load_dwordx4 v[140:143], v4, s[36:39], s77 offen nt
  s_add_u32 s77, s77, 4096
  v_subrev_f32 v48, s79, v36
  v_subrev_f32 v49, s79, v37
  v_subrev_f32 v50, s79, v38
  v_subrev_f32 v51, s79, v39
  v_subrev_f32 v52, s79, v40
  v_subrev_f32 v53, s79, v41
  v_subrev_f32 v54, s79, v42
  v_subrev_f32 v55, s79, v43
  v_subrev_f32 v56, s79, v44
  v_subrev_f32 v57, s79, v45
  v_add_f32 v60, v48, v49
  v_mul_f32 v61, v48, v48
  v_fmac_f32 v61, v49, v49
  v_add_f32 v60, v60, v50
  v_fmac_f32 v61, v50, v50
  v_add_f32 v60, v60, v51
  v_fmac_f32 v61, v51, v51
  v_add_f32 v60, v60, v52
  v_fmac_f32 v61, v52, v52
  v_add_f32 v60, v60, v53
  v_fmac_f32 v61, v53, v53
  v_add_f32 v60, v60, v54
  v_fmac_f32 v61, v54, v54
  v_add_f32 v60, v60, v55
  v_fmac_f32 v61, v55, v55
  v_add_f32 v60, v60, v56
  v_fmac_f32 v61, v56, v56
  v_add_f32 v60, v60, v57
  v_fmac_f32 v61, v57, v57
  buffer_load_dwordx4 v[144:147], v4, s[36:39], s77 offen nt
  s_add_u32 s77, s77, 4096
  buffer_load_dwordx4 v[148:151], v4, s[36:39], s77 offen nt
  s_add_u32 s77, s77, 4096
  s_nop 0
  v_add_f32_dpp v60, v60, v60 row_ror:8 row_mask:0xf bank_mask:0xf
  v_add_f32_dpp v61, v61, v61 row_ror:8 row_mask:0xf bank_mask:0xf
  s_nop 0
  v_add_f32_dpp v60, v60, v60 row_ror:4 row_mask:0xf bank_mask:0xf
  v_add_f32_dpp v61, v61, v61 row_ror:4 row_mask:0xf bank_mask:0xf
  s_nop 0
  v_add_f32_dpp v60, v60, v60 row_ror:2 row_mask:0xf bank_mask:0xf
  v_add_f32_dpp v61, v61, v61 row_ror:2 row_mask:0xf bank_mask:0xf
  s_nop 0
  v_add_f32_dpp v60, v60, v60 row_ror:1 row_mask:0xf bank_mask:0xf
  v_add_f32_dpp v61, v61, v61 row_ror:1 row_mask:0xf bank_mask:0xf
  s_nop 0
  v_mov_b32 v62, v60
  v_mov_b32 v63, v61
  s_nop 0
  v_permlane16_swap_b32 v60, v62
  v_permlane16_swap_b32 v61, v63
  s_nop 0
  v_add_f32 v60, v60, v62
  v_add_f32 v61, v61, v63
  v_mov_b32 v62, v60
  v_mov_b32 v63, v61
  s_nop 0
  v_permlane32_swap_b32 v60, v62
  v_permlane32_swap_b32 v61, v63
  s_nop 0
  v_add_f32 v60, v60, v62
  v_add_f32 v61, v61, v63
  buffer_load_dwordx4 v[152:155], v4, s[36:39], s77 offen nt
  s_add_u32 s77, s77, 4096
  buffer_load_dwordx4 v[156:159], v4, s[36:39], s77 offen nt
  s_add_u32 s77, s77, 4096
  v_mul_f32 v60, 0x3acccccd, v60
  v_mul_f32 v61, 0x3acccccd, v61
  v_add_f32 v65, s79, v60
  v_fma_f32 v61, -v60, v60, v61
  v_cvt_pk_bf16_f32 v62, v65, v65
  v_and_b32 v65, 0xffff0000, v62
  v_cvt_pk_bf16_f32 v63, v61, v61
  v_and_b32 v61, 0xffff0000, v63
  v_add_f32 v61, 0x3727c5ac, v61
  v_cvt_pk_bf16_f32 v63, v61, v61
  v_and_b32 v61, 0xffff0000, v63
  v_sqrt_f32 v70, v61
  s_nop 0
  v_cvt_pk_bf16_f32 v63, v70, v70
  v_and_b32 v70, 0xffff0000, v63
  v_rcp_f32 v69, v70
  buffer_load_dwordx4 v[160:163], v4, s[36:39], s77 offen nt
  s_add_u32 s77, s77, 4096
  buffer_load_dwordx4 v[164:167], v4, s[36:39], s77 offen nt
  s_add_u32 s77, s77, 4096
  v_sub_f32 v48, v36, v65
  v_sub_f32 v49, v37, v65
  v_sub_f32 v50, v38, v65
  v_sub_f32 v51, v39, v65
  v_sub_f32 v52, v40, v65
  v_sub_f32 v53, v41, v65
  v_sub_f32 v54, v42, v65
  v_sub_f32 v55, v43, v65
  v_sub_f32 v56, v44, v65
  v_sub_f32 v57, v45, v65
  v_cvt_pk_bf16_f32 v26, v48, v49
  v_cvt_pk_bf16_f32 v27, v50, v51
  v_cvt_pk_bf16_f32 v28, v52, v53
  v_cvt_pk_bf16_f32 v29, v54, v55
  v_cvt_pk_bf16_f32 v30, v56, v57
  v_lshlrev_b32 v48, 16, v26
  v_and_b32 v49, 0xffff0000, v26
  v_lshlrev_b32 v50, 16, v27
  v_and_b32 v51, 0xffff0000, v27
  v_lshlrev_b32 v52, 16, v28
  v_and_b32 v53, 0xffff0000, v28
  v_lshlrev_b32 v54, 16, v29
  v_and_b32 v55, 0xffff0000, v29
  v_lshlrev_b32 v56, 16, v30
  v_and_b32 v57, 0xffff0000, v30
  v_mul_f32 v48, v48, v69
  v_mul_f32 v49, v49, v69
  v_mul_f32 v50, v50, v69
  v_mul_f32 v51, v51, v69
  v_mul_f32 v52, v52, v69
  v_mul_f32 v53, v53, v69
  v_mul_f32 v54, v54, v69
  v_mul_f32 v55, v55, v69
  v_mul_f32 v56, v56, v69
  v_mul_f32 v57, v57, v69
  v_cvt_pk_bf16_f32 v48, v48, v48
  v_cvt_pk_bf16_f32 v49, v49, v49
  v_cvt_pk_bf16_f32 v50, v50, v50
  v_cvt_pk_bf16_f32 v51, v51, v51
  v_cvt_pk_bf16_f32 v52, v52, v52
  v_cvt_pk_bf16_f32 v53, v53, v53
  v_cvt_pk_bf16_f32 v54, v54, v54
  v_cvt_pk_bf16_f32 v55, v55, v55
  v_cvt_pk_bf16_f32 v56, v56, v56
  v_cvt_pk_bf16_f32 v57, v57, v57
  ds_write_b32 v66, v48 offset:0
  ds_write_b32 v66, v49 offset:640
  ds_write_b32 v66, v50 offset:128
  ds_write_b32 v66, v51 offset:768
  ds_write_b32 v66, v52 offset:256
  ds_write_b32 v66, v53 offset:896
  ds_write_b32 v66, v54 offset:384
  ds_write_b32 v66, v55 offset:1024
  ds_write_b32 v66, v56 offset:512
  ds_write_b32 v66, v57 offset:1152
  buffer_load_dwordx4 v[168:171], v4, s[36:39], s77 offen nt
  s_add_u32 s77, s77, 4096
  buffer_load_dwordx4 v[172:175], v4, s[36:39], s77 offen nt
  s_add_u32 s77, s77, 4096
  s_waitcnt lgkmcnt(0)
  s_add_u32 s68, s68, 1
  s_add_u32 s69, s69, 0x61c88647
  s_barrier
  ds_read_b32 v16, v67 offset:0
  ds_read_b32 v17, v67 offset:4
  ds_read_b32 v18, v67 offset:8
  ds_read_b32 v19, v67 offset:12
  ds_read_b32 v20, v67 offset:16
  ds_read_b32 v21, v67 offset:5120
  ds_read_b32 v22, v67 offset:5124
  ds_read_b32 v23, v67 offset:5128
  ds_read_b32 v24, v67 offset:5132
  ds_read_b32 v25, v67 offset:5136
  v_lshrrev_b32 v71, 1, v3
  s_lshl_b32 s79, s72, 2
  v_add_u32 v71, s79, v71
  v_lshlrev_b32 v71, 7, v71
  v_lshl_add_u32 v71, v2, 3, v71
  v_and_b32 v72, 1, v3
  v_lshl_add_u32 v71, v72, 2, v71
  v_lshlrev_b32 v71, 2, v71
  s_waitcnt vmcnt(12) lgkmcnt(0)
  v_and_b32 v84, v16, v96
  v_and_b32 v85, v16, v97
  v_and_b32 v86, v16, v98
  v_and_b32 v87, v16, v99
  v_and_b32 v88, v21, v96
  v_and_b32 v89, v21, v97
  v_and_b32 v90, v21, v98
  v_and_b32 v91, v21, v99
  v_mfma_f32_16x16x32_bf16 a[236:239], v[84:87], a[0:3], 0
  v_and_b32 v84, v17, v96
  v_and_b32 v85, v17, v97
  v_and_b32 v86, v17, v98
  v_and_b32 v87, v17, v99
  v_mfma_f32_16x16x32_bf16 a[240:243], v[88:91], a[0:3], 0
  v_and_b32 v88, v22, v96
  v_and_b32 v89, v22, v97
  v_and_b32 v90, v22, v98
  v_and_b32 v91, v22, v99
  v_mfma_f32_16x16x32_bf16 a[236:239], v[84:87], a[4:7], a[236:239]
  v_and_b32 v84, v18, v96
  v_and_b32 v85, v18, v97
  v_and_b32 v86, v18, v98
  v_and_b32 v87, v18, v99
  v_mfma_f32_16x16x32_bf16 a[240:243], v[88:91], a[4:7], a[240:243]
  v_and_b32 v88, v23, v96
  v_and_b32 v89, v23, v97
  v_and_b32 v90, v23, v98
  v_and_b32 v91, v23, v99
  v_mfma_f32_16x16x32_bf16 a[236:239], v[84:87], a[8:11], a[236:239]
  v_and_b32 v84, v19, v96
  v_and_b32 v85, v19, v97
  v_and_b32 v86, v19, v98
  v_and_b32 v87, v19, v99
  v_mfma_f32_16x16x32_bf16 a[240:243], v[88:91], a[8:11], a[240:243]
  v_and_b32 v88, v24, v96
  v_and_b32 v89, v24, v97
  v_and_b32 v90, v24, v98
  v_and_b32 v91, v24, v99
  v_mfma_f32_16x16x32_bf16 a[236:239], v[84:87], a[12:15], a[236:239]
  v_and_b32 v84, v20, v96
  v_and_b32 v85, v20, v97
  v_and_b32 v86, v20, v98
  v_and_b32 v87, v20, v99
  v_mfma_f32_16x16x32_bf16 a[240:243], v[88:91], a[12:15], a[240:243]
  v_and_b32 v88, v25, v96
  v_and_b32 v89, v25, v97
  v_and_b32 v90, v25, v98
  v_and_b32 v91, v25, v99
  v_mfma_f32_16x16x32_bf16 a[236:239], v[84:87], a[16:19], a[236:239]
  s_nop 1
  v_mfma_f32_16x16x32_bf16 a[240:243], v[88:91], a[16:19], a[240:243]
  s_cmp_eq_u32 s96, 1
  s_cbranch_scc0 L_nof1
  buffer_load_dwordx4 a[20:23], v7, s[48:51], s78 offen
  s_add_u32 s78, s78, 27648
  buffer_load_dwordx4 a[24:27], v7, s[48:51], s78 offen
  s_add_u32 s78, s78, 27648
  buffer_load_dwordx4 a[28:31], v7, s[48:51], s78 offen
  s_add_u32 s78, s78, 27648
  buffer_load_dwordx4 a[32:35], v7, s[48:51], s78 offen
  s_add_u32 s78, s78, 27648
  buffer_load_dwordx4 a[36:39], v7, s[48:51], s78 offen
  s_add_u32 s78, s78, 27648
  buffer_load_dwordx4 a[40:43], v7, s[48:51], s78 offen
  s_add_u32 s78, s78, 27648
  buffer_load_dwordx4 a[44:47], v7, s[48:51], s78 offen
  s_add_u32 s78, s78, 27648
  buffer_load_dwordx4 a[48:51], v7, s[48:51], s78 offen
  s_add_u32 s78, s78, 27648
  buffer_load_dwordx4 a[52:55], v7, s[48:51], s78 offen
  s_add_u32 s78, s78, 27648
  buffer_load_dwordx4 a[56:59], v7, s[48:51], s78 offen
L_nof1:
  s_nop 7
  ds_write_b128 v71, a[236:239] offset:10240
  ds_write_b128 v71, a[240:243] offset:11264
  v_lshlrev_b32 v72, 3, v1
  s_lshl_b32 s79, s72, 9
  v_add_u32 v72, s79, v72
  s_waitcnt lgkmcnt(0)
  s_barrier
  ds_read_b64 v[48:49], v72 offset:10240
  ds_read_b64 v[50:51], v72 offset:12288
  ds_read_b64 v[52:53], v72 offset:14336
  ds_read_b64 v[54:55], v72 offset:16384
  s_lshl_b32 s79, s73, 2
  s_add_u32 s79, s79, s72
  s_lshl_b32 s79, s79, 3
  s_add_u32 s79, s79, s3
  s_lshl_b32 s79, s79, 10
  s_add_u32 s79, s79, 0
  v_lshlrev_b32 v64, 4, v1
  v_mov_b32 v57, s68
  v_mov_b32 v59, s69
  s_waitcnt lgkmcnt(0)
  v_add_f32 v48, v48, v50
  v_add_f32 v49, v49, v51
  v_add_f32 v52, v52, v54
  v_add_f32 v53, v53, v55
  v_add_f32 v56, v48, v52
  v_add_f32 v58, v49, v53
  buffer_store_dwordx4 v[56:59], v64, s[56:59], s79 offen sc1
  buffer_load_dwordx4 v[176:179], v4, s[36:39], s77 offen nt
  s_add_u32 s77, s77, 4096
  buffer_load_dwordx4 v[180:183], v4, s[36:39], s77 offen nt
  s_add_u32 s77, s77, 4096
  s_cmp_eq_u32 s96, 1
  s_cbranch_scc0 L_nof2
  ds_read_b32 v26, v68 offset:0
  ds_read_b32 v27, v68 offset:2560
  ds_read_b32 v28, v68 offset:5120
  ds_read_b32 v29, v68 offset:7680
  ds_read_b32 v30, v68 offset:8
  ds_read_b32 v31, v68 offset:2568
  ds_read_b32 v32, v68 offset:5128
  ds_read_b32 v33, v68 offset:7688
  ds_read_b32 v34, v68 offset:16
  ds_read_b32 v35, v68 offset:2576
  ds_read_b32 v36, v68 offset:5136
  ds_read_b32 v37, v68 offset:7696
  ds_read_b32 v38, v68 offset:24
  ds_read_b32 v39, v68 offset:2584
  ds_read_b32 v40, v68 offset:5144
  ds_read_b32 v41, v68 offset:7704
  ds_read_b32 v42, v68 offset:32
  ds_read_b32 v43, v68 offset:2592
  ds_read_b32 v44, v68 offset:5152
  ds_read_b32 v45, v68 offset:7712
  v_bfe_u32 v73, v1, 3, 1
  v_lshlrev_b32 v73, 6, v73
  v_and_b32 v72, 7, v1
  v_lshl_add_u32 v73, v72, 3, v73
  v_and_b32 v72, 1, v3
  v_lshl_add_u32 v73, v72, 2, v73
  s_lshl_b32 s79, s72, 9
  v_add_lshl_u32 v73, v73, s79, 2
  s_waitcnt vmcnt(3) lgkmcnt(0)
  v_and_b32 v84, v26, v96
  v_and_b32 v85, v26, v97
  v_and_b32 v86, v26, v98
  v_and_b32 v87, v26, v99
  v_and_b32 v88, v27, v96
  v_and_b32 v89, v27, v97
  v_and_b32 v90, v27, v98
  v_and_b32 v91, v27, v99
  v_mfma_f32_16x16x32_bf16 a[220:223], v[84:87], a[20:23], 0
  v_and_b32 v84, v28, v96
  v_and_b32 v85, v28, v97
  v_and_b32 v86, v28, v98
  v_and_b32 v87, v28, v99
  v_mfma_f32_16x16x32_bf16 a[224:227], v[88:91], a[20:23], 0
  v_and_b32 v88, v29, v96
  v_and_b32 v89, v29, v97
  v_and_b32 v90, v29, v98
  v_and_b32 v91, v29, v99
  v_mfma_f32_16x16x32_bf16 a[228:231], v[84:87], a[20:23], 0
  v_and_b32 v84, v30, v96
  v_and_b32 v85, v30, v97
  v_and_b32 v86, v30, v98
  v_and_b32 v87, v30, v99
  v_mfma_f32_16x16x32_bf16 a[232:235], v[88:91], a[20:23], 0
  v_and_b32 v88, v31, v96
  v_and_b32 v89, v31, v97
  v_and_b32 v90, v31, v98
  v_and_b32 v91, v31, v99
  v_mfma_f32_16x16x32_bf16 a[220:223], v[84:87], a[24:27], a[220:223]
  v_and_b32 v84, v32, v96
  v_and_b32 v85, v32, v97
  v_and_b32 v86, v32, v98
  v_and_b32 v87, v32, v99
  v_mfma_f32_16x16x32_bf16 a[224:227], v[88:91], a[24:27], a[224:227]
  v_and_b32 v88, v33, v96
  v_and_b32 v89, v33, v97
  v_and_b32 v90, v33, v98
  v_and_b32 v91, v33, v99
  v_mfma_f32_16x16x32_bf16 a[228:231], v[84:87], a[24:27], a[228:231]
  v_and_b32 v84, v34, v96
  v_and_b32 v85, v34, v97
  v_and_b32 v86, v34, v98
  v_and_b32 v87, v34, v99
  v_mfma_f32_16x16x32_bf16 a[232:235], v[88:91], a[24:27], a[232:235]
  v_and_b32 v88, v35, v96
  v_and_b32 v89, v35, v97
  v_and_b32 v90, v35, v98
  v_and_b32 v91, v35, v99
  v_mfma_f32_16x16x32_bf16 a[220:223], v[84:87], a[28:31], a[220:223]
  v_and_b32 v84, v36, v96
  v_and_b32 v85, v36, v97
  v_and_b32 v86, v36, v98
  v_and_b32 v87, v36, v99
  v_mfma_f32_16x16x32_bf16 a[224:227], v[88:91], a[28:31], a[224:227]
  v_and_b32 v88, v37, v96
  v_and_b32 v89, v37, v97
  v_and_b32 v90, v37, v98
  v_and_b32 v91, v37, v99
  v_mfma_f32_16x16x32_bf16 a[228:231], v[84:87], a[28:31], a[228:231]
  v_and_b32 v84, v38, v96
  v_and_b32 v85, v38, v97
  v_and_b32 v86, v38, v98
  v_and_b32 v87, v38, v99
  v_mfma_f32_16x16x32_bf16 a[232:235], v[88:91], a[28:31], a[232:235]
  v_and_b32 v88, v39, v96
  v_and_b32 v89, v39, v97
  v_and_b32 v90, v39, v98
  v_and_b32 v91, v39, v99
  v_mfma_f32_16x16x32_bf16 a[220:223], v[84:87], a[32:35], a[220:223]
  v_and_b32 v84, v40, v96
  v_and_b32 v85, v40, v97
  v_and_b32 v86, v40, v98
  v_and_b32 v87, v40, v99
  v_mfma_f32_16x16x32_bf16 a[224:227], v[88:91], a[32:35], a[224:227]
  v_and_b32 v88, v41, v96
  v_and_b32 v89, v41, v97
  v_and_b32 v90, v41, v98
  v_and_b32 v91, v41, v99
  v_mfma_f32_16x16x32_bf16 a[228:231], v[84:87], a[32:35], a[228:231]
  v_and_b32 v84, v42, v96
  v_and_b32 v85, v42, v97
  v_and_b32 v86, v42, v98
  v_and_b32 v87, v42, v99
  v_mfma_f32_16x16x32_bf16 a[232:235], v[88:91], a[32:35], a[232:235]
  v_and_b32 v88, v43, v96
  v_and_b32 v89, v43, v97
  v_and_b32 v90, v43, v98
  v_and_b32 v91, v43, v99
  v_mfma_f32_16x16x32_bf16 a[220:223], v[84:87], a[36:39], a[220:223]
  v_and_b32 v84, v44, v96
  v_and_b32 v85, v44, v97
  v_and_b32 v86, v44, v98
  v_and_b32 v87, v44, v99
  v_mfma_f32_16x16x32_bf16 a[224:227], v[88:91], a[36:39], a[224:227]
  v_and_b32 v88, v45, v96
  v_and_b32 v89, v45, v97
  v_and_b32 v90, v45, v98
  v_and_b32 v91, v45, v99
  v_mfma_f32_16x16x32_bf16 a[228:231], v[84:87], a[36:39], a[228:231]
  s_nop 1
  v_mfma_f32_16x16x32_bf16 a[232:235], v[88:91], a[36:39], a[232:235]
  ds_read_b32 v26, v68 offset:40
  ds_read_b32 v27, v68 offset:2600
  ds_read_b32 v28, v68 offset:5160
  ds_read_b32 v29, v68 offset:7720
  ds_read_b32 v30, v68 offset:48
  ds_read_b32 v31, v68 offset:2608
  ds_read_b32 v32, v68 offset:5168
  ds_read_b32 v33, v68 offset:7728
  ds_read_b32 v34, v68 offset:56
  ds_read_b32 v35, v68 offset:2616
  ds_read_b32 v36, v68 offset:5176
  ds_read_b32 v37, v68 offset:7736
  ds_read_b32 v38, v68 offset:64
  ds_read_b32 v39, v68 offset:2624
  ds_read_b32 v40, v68 offset:5184
  ds_read_b32 v41, v68 offset:7744
  ds_read_b32 v42, v68 offset:72
  ds_read_b32 v43, v68 offset:2632
  ds_read_b32 v44, v68 offset:5192
  ds_read_b32 v45, v68 offset:7752
  s_waitcnt lgkmcnt(0)
  v_and_b32 v84, v26, v96
  v_and_b32 v85, v26, v97
  v_and_b32 v86, v26, v98
  v_and_b32 v87, v26, v99
  v_and_b32 v88, v27, v96
  v_and_b32 v89, v27, v97
  v_and_b32 v90, v27, v98
  v_and_b32 v91, v27, v99
  v_mfma_f32_16x16x32_bf16 a[220:223], v[84:87], a[40:43], a[220:223]
  v_and_b32 v84, v28, v96
  v_and_b32 v85, v28, v97
  v_and_b32 v86, v28, v98
  v_and_b32 v87, v28, v99
  v_mfma_f32_16x16x32_bf16 a[224:227], v[88:91], a[40:43], a[224:227]
  v_and_b32 v88, v29, v96
  v_and_b32 v89, v29, v97
  v_and_b32 v90, v29, v98
  v_and_b32 v91, v29, v99
  v_mfma_f32_16x16x32_bf16 a[228:231], v[84:87], a[40:43], a[228:231]
  v_and_b32 v84, v30, v96
  v_and_b32 v85, v30, v97
  v_and_b32 v86, v30, v98
  v_and_b32 v87, v30, v99
  v_mfma_f32_16x16x32_bf16 a[232:235], v[88:91], a[40:43], a[232:235]
  v_and_b32 v88, v31, v96
  v_and_b32 v89, v31, v97
  v_and_b32 v90, v31, v98
  v_and_b32 v91, v31, v99
  v_mfma_f32_16x16x32_bf16 a[220:223], v[84:87], a[44:47], a[220:223]
  v_and_b32 v84, v32, v96
  v_and_b32 v85, v32, v97
  v_and_b32 v86, v32, v98
  v_and_b32 v87, v32, v99
  v_mfma_f32_16x16x32_bf16 a[224:227], v[88:91], a[44:47], a[224:227]
  v_and_b32 v88, v33, v96
  v_and_b32 v89, v33, v97
  v_and_b32 v90, v33, v98
  v_and_b32 v91, v33, v99
  v_mfma_f32_16x16x32_bf16 a[228:231], v[84:87], a[44:47], a[228:231]
  v_and_b32 v84, v34, v96
  v_and_b32 v85, v34, v97
  v_and_b32 v86, v34, v98
  v_and_b32 v87, v34, v99
  v_mfma_f32_16x16x32_bf16 a[232:235], v[88:91], a[44:47], a[232:235]
  v_and_b32 v88, v35, v96
  v_and_b32 v89, v35, v97
  v_and_b32 v90, v35, v98
  v_and_b32 v91, v35, v99
  v_mfma_f32_16x16x32_bf16 a[220:223], v[84:87], a[48:51], a[220:223]
  v_and_b32 v84, v36, v96
  v_and_b32 v85, v36, v97
  v_and_b32 v86, v36, v98
  v_and_b32 v87, v36, v99
  v_mfma_f32_16x16x32_bf16 a[224:227], v[88:91], a[48:51], a[224:227]
  v_and_b32 v88, v37, v96
  v_and_b32 v89, v37, v97
  v_and_b32 v90, v37, v98
  v_and_b32 v91, v37, v99
  v_mfma_f32_16x16x32_bf16 a[228:231], v[84:87], a[48:51], a[228:231]
  v_and_b32 v84, v38, v96
  v_and_b32 v85, v38, v97
  v_and_b32 v86, v38, v98
  v_and_b32 v87, v38, v99
  v_mfma_f32_16x16x32_bf16 a[232:235], v[88:91], a[48:51], a[232:235]
  v_and_b32 v88, v39, v96
  v_and_b32 v89, v39, v97
  v_and_b32 v90, v39, v98
  v_and_b32 v91, v39, v99
  v_mfma_f32_16x16x32_bf16 a[220:223], v[84:87], a[52:55], a[220:223]
  v_and_b32 v84, v40, v96
  v_and_b32 v85, v40, v97
  v_and_b32 v86, v40, v98
  v_and_b32 v87, v40, v99
  v_mfma_f32_16x16x32_bf16 a[224:227], v[88:91], a[52:55], a[224:227]
  v_and_b32 v88, v41, v96
  v_and_b32 v89, v41, v97
  v_and_b32 v90, v41, v98
  v_and_b32 v91, v41, v99
  v_mfma_f32_16x16x32_bf16 a[228:231], v[84:87], a[52:55], a[228:231]
  v_and_b32 v84, v42, v96
  v_and_b32 v85, v42, v97
  v_and_b32 v86, v42, v98
  v_and_b32 v87, v42, v99
  v_mfma_f32_16x16x32_bf16 a[232:235], v[88:91], a[52:55], a[232:235]
  v_and_b32 v88, v43, v96
  v_and_b32 v89, v43, v97
  v_and_b32 v90, v43, v98
  v_and_b32 v91, v43, v99
  v_mfma_f32_16x16x32_bf16 a[220:223], v[84:87], a[56:59], a[220:223]
  v_and_b32 v84, v44, v96
  v_and_b32 v85, v44, v97
  v_and_b32 v86, v44, v98
  v_and_b32 v87, v44, v99
  v_mfma_f32_16x16x32_bf16 a[224:227], v[88:91], a[56:59], a[224:227]
  v_and_b32 v88, v45, v96
  v_and_b32 v89, v45, v97
  v_and_b32 v90, v45, v98
  v_and_b32 v91, v45, v99
  v_mfma_f32_16x16x32_bf16 a[228:231], v[84:87], a[56:59], a[228:231]
  s_nop 1
  v_mfma_f32_16x16x32_bf16 a[232:235], v[88:91], a[56:59], a[232:235]
  s_nop 7
  s_mov_b64 exec, s[88:89]
  ds_write_b128 v73, a[220:223] offset:18432
  ds_write_b128 v73, a[224:227] offset:18944
  ds_write_b128 v73, a[228:231] offset:19456
  ds_write_b128 v73, a[232:235] offset:19968
  s_mov_b64 exec, -1
L_nof2:
  buffer_load_dwordx4 v[184:187], v4, s[36:39], s77 offen nt
  s_add_u32 s77, s77, 4096
  buffer_load_dwordx4 v[188:191], v4, s[36:39], s77 offen nt
  s_add_u32 s77, s77, 4096
  s_lshl_b32 s79, s73, 2
  s_add_u32 s79, s79, s75
  s_lshl_b32 s79, s79, 3
  s_lshl_b32 s80, s72, 1
  s_add_u32 s79, s79, s80
  s_lshl_b32 s79, s79, 10
  s_add_u32 s80, s79, 0
  buffer_load_dwordx4 v[16:19], v64, s[56:59], s80 offen sc1
  buffer_load_dwordx4 v[20:23], v64, s[56:59], s80 offen offset:1024 sc1
  buffer_load_dwordx4 v[192:195], v4, s[36:39], s77 offen nt
  s_add_u32 s77, s77, 4096
  buffer_load_dwordx4 v[196:199], v4, s[36:39], s77 offen nt
  s_add_u32 s77, s77, 4096
  buffer_load_dwordx4 v[200:203], v4, s[36:39], s77 offen nt
  s_add_u32 s77, s77, 4096
  buffer_load_dwordx4 v[204:207], v4, s[36:39], s77 offen nt
  s_add_u32 s77, s77, 4096
  buffer_load_dwordx4 v[208:211], v4, s[36:39], s77 offen nt
  s_add_u32 s77, s77, 4096
  buffer_load_dwordx4 v[212:215], v4, s[36:39], s77 offen nt
  s_add_u32 s77, s77, 4096
  buffer_load_dwordx4 v[216:219], v4, s[36:39], s77 offen nt
  s_add_u32 s77, s77, 4096
  buffer_load_dwordx4 v[220:223], v4, s[36:39], s77 offen nt
  s_add_u32 s77, s77, 4096
  buffer_load_dwordx4 v[224:227], v4, s[36:39], s77 offen nt
  s_add_u32 s77, s77, 4096
  buffer_load_dwordx4 v[228:231], v4, s[36:39], s77 offen nt
  s_add_u32 s77, s77, 4096
  buffer_load_dwordx4 v[232:235], v4, s[36:39], s77 offen nt
  s_add_u32 s77, s77, 4096
  buffer_load_dwordx4 v[236:239], v4, s[36:39], s77 offen nt
  s_add_u32 s77, s77, 4096
  buffer_load_dwordx4 v[240:243], v4, s[36:39], s77 offen nt
  s_add_u32 s77, s77, 4096
  buffer_load_dwordx4 v[244:247], v4, s[36:39], s77 offen nt
  s_add_u32 s77, s77, 4096
  buffer_load_dwordx4 v[248:251], v4, s[36:39], s77 offen nt
  s_add_u32 s77, s77, 4096
  buffer_load_dwordx4 v[252:255], v4, s[36:39], s77 offen nt
  s_add_u32 s77, s77, 4096
  s_waitcnt vmcnt(16)
  s_mov_b32 s90, 0
L_sp0:
  v_xor_b32 v17, s68, v17
  v_xor_b32 v19, s69, v19
  v_or_b32 v24, v17, v19
  v_xor_b32 v21, s68, v21
  v_xor_b32 v23, s69, v23
  v_or3_b32 v24, v24, v21, v23
  v_cmp_ne_u32 vcc, 0, v24
  s_nop 4
  s_cbranch_vccz L_spd0
  s_add_u32 s90, s90, 1
  s_cmp_ge_u32 s90, 100000
  s_cbranch_scc1 L_spd0
  s_sleep 2
  buffer_load_dwordx4 v[16:19], v64, s[56:59], s80 offen sc1
  buffer_load_dwordx4 v[20:23], v64, s[56:59], s80 offen offset:1024 sc1
  s_waitcnt vmcnt(0)
  s_branch L_sp0
L_spd0:
  v_add_f32 v26, v16, v20
  v_add_f32 v27, v18, v22
  v_lshlrev_b32 v28, 3, v1
  s_lshl_b32 s79, s72, 9
  v_add_u32 v28, s79, v28
  ds_write_b64 v28, v[26:27] offset:26624
  v_lshlrev_b32 v76, 5, v2
  v_and_b32 v77, 31, v1
  v_lshlrev_b32 v77, 3, v77
  v_add_u32 v77, s79, v77
  s_waitcnt lgkmcnt(0)
  s_barrier
  ds_read_b128 v[16:19], v76 offset:26624
  ds_read_b128 v[20:23], v76 offset:26640
  ds_read_b128 v[24:27], v76 offset:27136
  ds_read_b128 v[28:31], v76 offset:27152
  ds_read_b128 v[32:35], v76 offset:27648
  ds_read_b128 v[36:39], v76 offset:27664
  ds_read_b128 v[40:43], v76 offset:28160
  ds_read_b128 v[44:47], v76 offset:28176
  ds_read_b64 v[48:49], v77 offset:18432
  ds_read_b64 v[50:51], v77 offset:18688
  ds_read_b64 v[52:53], v77 offset:20480
  ds_read_b64 v[54:55], v77 offset:20736
  ds_read_b64 v[56:57], v77 offset:22528
  ds_read_b64 v[58:59], v77 offset:22784
  ds_read_b64 v[60:61], v77 offset:24576
  ds_read_b64 v[62:63], v77 offset:24832
  s_and_b32 s79, s95, 1
  s_lshl_b32 s79, s79, 1
  s_bfe_u32 s81, s95, 0x10001
  s_add_u32 s79, s79, s81
  s_lshl_b32 s79, s79, 2
  s_add_u32 s79, s79, s72
  s_mul_i32 s79, s79, 13824
  s_lshl_b32 s81, s94, 9
  s_add_u32 s79, s79, s81
  s_add_u32 s79, s79, 1048576
  s_waitcnt lgkmcnt(8)
  v_add_f32 v16, v16, v24
  v_add_f32 v32, v32, v40
  v_add_f32 v17, v17, v25
  v_add_f32 v33, v33, v41
  v_add_f32 v18, v18, v26
  v_add_f32 v34, v34, v42
  v_add_f32 v19, v19, v27
  v_add_f32 v35, v35, v43
  v_add_f32 v20, v20, v28
  v_add_f32 v36, v36, v44
  v_add_f32 v21, v21, v29
  v_add_f32 v37, v37, v45
  v_add_f32 v22, v22, v30
  v_add_f32 v38, v38, v46
  v_add_f32 v23, v23, v31
  v_add_f32 v39, v39, v47
  v_add_f32 v16, v16, v32
  v_add_f32 v17, v17, v33
  v_add_f32 v18, v18, v34
  v_add_f32 v19, v19, v35
  v_add_f32 v20, v20, v36
  v_add_f32 v21, v21, v37
  v_add_f32 v22, v22, v38
  v_add_f32 v23, v23, v39
  v_cvt_pk_bf16_f32 v100, v16, v17
  v_cvt_pk_bf16_f32 v101, v18, v19
  v_cvt_pk_bf16_f32 v102, v20, v21
  v_cvt_pk_bf16_f32 v103, v22, v23
  s_waitcnt lgkmcnt(0)
  v_add_f32 v48, v48, v50
  v_add_f32 v52, v52, v54
  v_add_f32 v56, v56, v58
  v_add_f32 v60, v60, v62
  v_add_f32 v48, v48, v52
  v_add_f32 v56, v56, v60
  v_add_f32 v49, v49, v51
  v_add_f32 v53, v53, v55
  v_add_f32 v57, v57, v59
  v_add_f32 v61, v61, v63
  v_add_f32 v49, v49, v53
  v_add_f32 v57, v57, v61
  v_add_f32 v68, v48, v56
  v_add_f32 v70, v49, v57
  v_mov_b32 v69, s68
  v_mov_b32 v71, s69
  s_cmp_eq_u32 s96, 1
  s_cbranch_scc0 L_nofpub
  s_mov_b32 exec_hi, 0
  buffer_store_dwordx4 v[68:71], v64, s[56:59], s79 offen sc1
  s_mov_b32 exec_hi, -1
L_nofpub:
  s_lshl_b32 s79, s73, 7
  s_lshl_b32 s81, s72, 5
  s_add_u32 s79, s79, s81
  s_mul_i32 s92, s79, 1280
  s_mov_b32 s95, 0x3db504f3
  s_call_b64 s[82:83], L_kbody
  v_cvt_pk_bf16_f32 v16, v14, v15
  v_lshlrev_b32 v104, 16, v16
  v_and_b32 v105, 0xffff0000, v16
  v_mul_f32 v104, s95, v104
  v_mul_f32 v105, s95, v105
  v_cvt_pk_bf16_f32 v16, v104, v105
  v_lshlrev_b32 v104, 16, v16
  v_and_b32 v105, 0xffff0000, v16
  v_max_f32 v11, v104, v105
  buffer_load_dwordx4 a[0:3], v6, s[44:47], s92 offen offset:0
  buffer_load_dwordx4 a[4:7], v6, s[44:47], s92 offen offset:256
  buffer_load_dwordx4 a[8:11], v6, s[44:47], s92 offen offset:512
  buffer_load_dwordx4 a[12:15], v6, s[44:47], s92 offen offset:768
  buffer_load_dwordx4 a[16:19], v6, s[44:47], s92 offen offset:1024
  s_add_u32 s92, s92, 5120
  buffer_load_dwordx4 a[20:23], v6, s[44:47], s92 offen offset:0
  buffer_load_dwordx4 a[24:27], v6, s[44:47], s92 offen offset:256
  buffer_load_dwordx4 a[28:31], v6, s[44:47], s92 offen offset:512
  buffer_load_dwordx4 a[32:35], v6, s[44:47], s92 offen offset:768
  buffer_load_dwordx4 a[36:39], v6, s[44:47], s92 offen offset:1024
  s_add_u32 s92, s92, 5120
  s_call_b64 s[82:83], L_kbody
  v_cvt_pk_bf16_f32 v16, v14, v15
  v_lshlrev_b32 v106, 16, v16
  v_and_b32 v107, 0xffff0000, v16
  v_mul_f32 v106, s95, v106
  v_mul_f32 v107, s95, v107
  v_cvt_pk_bf16_f32 v16, v106, v107
  v_lshlrev_b32 v106, 16, v16
  v_and_b32 v107, 0xffff0000, v16
  v_max3_f32 v11, v11, v106, v107
  buffer_load_dwordx4 a[40:43], v6, s[44:47], s92 offen offset:0
  buffer_load_dwordx4 a[44:47], v6, s[44:47], s92 offen offset:256
  buffer_load_dwordx4 a[48:51], v6, s[44:47], s92 offen offset:512
  buffer_load_dwordx4 a[52:55], v6, s[44:47], s92 offen offset:768
  buffer_load_dwordx4 a[56:59], v6, s[44:47], s92 offen offset:1024
  s_add_u32 s92, s92, 5120
  buffer_load_dwordx4 a[60:63], v6, s[44:47], s92 offen offset:0
  buffer_load_dwordx4 a[64:67], v6, s[44:47], s92 offen offset:256
  buffer_load_dwordx4 a[68:71], v6, s[44:47], s92 offen offset:512
  buffer_load_dwordx4 a[72:75], v6, s[44:47], s92 offen offset:768
  buffer_load_dwordx4 a[76:79], v6, s[44:47], s92 offen offset:1024
  s_add_u32 s92, s92, 5120
  s_call_b64 s[82:83], L_kbody
  v_cvt_pk_bf16_f32 v16, v14, v15
  v_lshlrev_b32 v108, 16, v16
  v_and_b32 v109, 0xffff0000, v16
  v_mul_f32 v108, s95, v108
  v_mul_f32 v109, s95, v109
  v_cvt_pk_bf16_f32 v16, v108, v109
  v_lshlrev_b32 v108, 16, v16
  v_and_b32 v109, 0xffff0000, v16
  v_max3_f32 v11, v11, v108, v109
  buffer_load_dwordx4 a[80:83], v6, s[44:47], s92 offen offset:0
  buffer_load_dwordx4 a[84:87], v6, s[44:47], s92 offen offset:256
  buffer_load_dwordx4 a[88:91], v6, s[44:47], s92 offen offset:512
  buffer_load_dwordx4 a[92:95], v6, s[44:47], s92 offen offset:768
  buffer_load_dwordx4 a[96:99], v6, s[44:47], s92 offen offset:1024
  s_add_u32 s92, s92, 5120
  buffer_load_dwordx4 a[100:103], v6, s[44:47], s92 offen offset:0
  buffer_load_dwordx4 a[104:107], v6, s[44:47], s92 offen offset:256
  buffer_load_dwordx4 a[108:111], v6, s[44:47], s92 offen offset:512
  buffer_load_dwordx4 a[112:115], v6, s[44:47], s92 offen offset:768
  buffer_load_dwordx4 a[116:119], v6, s[44:47], s92 offen offset:1024
  s_add_u32 s92, s92, 5120
  s_mov_b32 s36, s32
  s_mov_b32 s37, s33
  s_mov_b32 s38, s34
  s_mov_b32 s39, s35
  s_mov_b32 s77, 0
  s_call_b64 s[82:83], L_kbody
  v_cvt_pk_bf16_f32 v16, v14, v15
  v_lshlrev_b32 v110, 16, v16
  v_and_b32 v111, 0xffff0000, v16
  v_mul_f32 v110, s95, v110
  v_mul_f32 v111, s95, v111
  v_cvt_pk_bf16_f32 v16, v110, v111
  v_lshlrev_b32 v110, 16, v16
  v_and_b32 v111, 0xffff0000, v16
  v_max3_f32 v11, v11, v110, v111
  s_nop 1
  v_max_f32_dpp v11, v11, v11 row_ror:8 row_mask:0xf bank_mask:0xf
  s_nop 1
  v_max_f32_dpp v11, v11, v11 row_ror:4 row_mask:0xf bank_mask:0xf
  s_nop 1
  v_max_f32_dpp v11, v11, v11 row_ror:2 row_mask:0xf bank_mask:0xf
  s_nop 1
  v_max_f32_dpp v11, v11, v11 row_ror:1 row_mask:0xf bank_mask:0xf
  v_mov_b32 v24, v11
  s_nop 1
  v_permlane16_swap_b32 v11, v24
  s_nop 1
  v_max_f32 v11, v11, v24
  v_mov_b32 v24, v11
  s_nop 1
  v_permlane32_swap_b32 v11, v24
  s_nop 1
  v_max_f32 v11, v11, v24
  v_sub_f32 v104, v104, v11
  v_sub_f32 v105, v105, v11
  v_sub_f32 v106, v106, v11
  v_sub_f32 v107, v107, v11
  v_sub_f32 v108, v108, v11
  v_sub_f32 v109, v109, v11
  v_sub_f32 v110, v110, v11
  v_sub_f32 v111, v111, v11
  v_mul_f32 v104, 0x3fb8aa3b, v104
  v_mul_f32 v105, 0x3fb8aa3b, v105
  v_mul_f32 v106, 0x3fb8aa3b, v106
  v_mul_f32 v107, 0x3fb8aa3b, v107
  v_mul_f32 v108, 0x3fb8aa3b, v108
  v_mul_f32 v109, 0x3fb8aa3b, v109
  v_mul_f32 v110, 0x3fb8aa3b, v110
  v_mul_f32 v111, 0x3fb8aa3b, v111
  v_exp_f32 v104, v104
  v_exp_f32 v105, v105
  v_exp_f32 v106, v106
  v_exp_f32 v107, v107
  v_exp_f32 v108, v108
  v_exp_f32 v109, v109
  v_exp_f32 v110, v110
  v_exp_f32 v111, v111
  v_mov_b32 v80, 0
  v_mov_b32 v81, 0
  v_mov_b32 v82, 0
  v_mov_b32 v83, 0
  v_add_f32 v12, v104, v105
  v_add_f32 v12, v12, v106
  v_add_f32 v12, v12, v107
  v_add_f32 v12, v12, v108
  v_add_f32 v12, v12, v109
  v_add_f32 v12, v12, v110
  v_add_f32 v12, v12, v111
  v_cvt_pk_bf16_f32 v104, v104, v104
  v_cvt_pk_bf16_f32 v105, v105, v105
  v_cvt_pk_bf16_f32 v106, v106, v106
  v_cvt_pk_bf16_f32 v107, v107, v107
  v_cvt_pk_bf16_f32 v108, v108, v108
  v_cvt_pk_bf16_f32 v109, v109, v109
  v_cvt_pk_bf16_f32 v110, v110, v110
  v_cvt_pk_bf16_f32 v111, v111, v111
  v_mov_b32 v14, v104
  v_mov_b32 v15, v105
  buffer_load_dwordx4 a[120:123], v6, s[44:47], s92 offen offset:0
  buffer_load_dwordx4 a[124:127], v6, s[44:47], s92 offen offset:256
  buffer_load_dwordx4 a[128:131], v6, s[44:47], s92 offen offset:512
  buffer_load_dwordx4 a[132:135], v6, s[44:47], s92 offen offset:768
  buffer_load_dwordx4 a[136:139], v6, s[44:47], s92 offen offset:1024
  s_add_u32 s92, s92, 5120
  buffer_load_dwordx4 a[140:143], v6, s[44:47], s92 offen offset:0
  buffer_load_dwordx4 a[144:147], v6, s[44:47], s92 offen offset:256
  buffer_load_dwordx4 a[148:151], v6, s[44:47], s92 offen offset:512
  buffer_load_dwordx4 a[152:155], v6, s[44:47], s92 offen offset:768
  buffer_load_dwordx4 a[156:159], v6, s[44:47], s92 offen offset:1024
  s_add_u32 s92, s92, 5120
  s_call_b64 s[82:83], L_vbody
  v_mov_b32 v14, v106
  v_mov_b32 v15, v107
  s_nop 1
  v_add_f32_dpp v12, v12, v12 row_ror:8 row_mask:0xf bank_mask:0xf
  s_nop 1
  v_add_f32_dpp v12, v12, v12 row_ror:4 row_mask:0xf bank_mask:0xf
  s_nop 1
  v_add_f32_dpp v12, v12, v12 row_ror:2 row_mask:0xf bank_mask:0xf
  s_nop 1
  v_add_f32_dpp v12, v12, v12 row_ror:1 row_mask:0xf bank_mask:0xf
  v_mov_b32 v24, v12
  s_nop 1
  v_permlane16_swap_b32 v12, v24
  s_nop 1
  v_add_f32 v12, v12, v24
  v_mov_b32 v24, v12
  s_nop 1
  v_permlane32_swap_b32 v12, v24
  s_nop 1
  v_add_f32 v12, v12, v24
  s_lshl_b32 s79, s76, 7
  s_lshl_b32 s81, s74, 2
  s_add_u32 s81, s81, s72
  s_lshl_b32 s81, s81, 4
  s_add_u32 s79, s79, s81
  s_add_u32 s79, s79, 1269760
  v_mov_b32 v16, v11
  v_mov_b32 v17, s68
  v_mov_b32 v18, v12
  v_mov_b32 v19, s69
  v_mov_b32 v20, 0
  s_mov_b64 exec, 1
  buffer_store_dwordx4 v[16:19], v20, s[56:59], s79 offen sc1
  s_mov_b64 exec, -1
  s_lshl_b32 s79, s73, 1
  s_add_u32 s79, s79, s74
  s_mul_i32 s95, s79, 27
  s_lshl_b32 s81, s72, 2
  s_add_u32 s79, s95, s81
  s_mul_i32 s80, s79, 1280
  buffer_load_dwordx4 a[160:163], v6, s[52:55], s80 offen offset:0
  buffer_load_dwordx4 a[164:167], v6, s[52:55], s80 offen offset:256
  buffer_load_dwordx4 a[168:171], v6, s[52:55], s80 offen offset:512
  buffer_load_dwordx4 a[172:175], v6, s[52:55], s80 offen offset:768
  buffer_load_dwordx4 a[176:179], v6, s[52:55], s80 offen offset:1024
  s_add_u32 s80, s80, 20480
  buffer_load_dwordx4 a[180:183], v6, s[52:55], s80 offen offset:0
  buffer_load_dwordx4 a[184:187], v6, s[52:55], s80 offen offset:256
  buffer_load_dwordx4 a[188:191], v6, s[52:55], s80 offen offset:512
  buffer_load_dwordx4 a[192:195], v6, s[52:55], s80 offen offset:768
  buffer_load_dwordx4 a[196:199], v6, s[52:55], s80 offen offset:1024
  v_lshl_add_u32 v76, v2, 4, v3
  v_add_u32 v76, s81, v76
  v_cmp_gt_u32 s[70:71], 27, v76
  v_add_u32 v76, s95, v76
  v_and_b32 v78, 1, v76
  v_lshrrev_b32 v76, 1, v76
  v_lshlrev_b32 v76, 4, v76
  s_mul_i32 s79, s75, 13824
  v_add_u32 v76, s79, v76
  v_mov_b32 v16, 0x7ffffff0
  v_cndmask_b32 v76, v16, v76, s[70:71]
  s_mov_b32 s79, 1048576
  buffer_load_dwordx4 v[24:27], v76, s[56:59], s79 offen sc1
  s_mov_b32 s79, 1103872
  buffer_load_dwordx4 v[28:31], v76, s[56:59], s79 offen sc1
  s_mov_b32 s79, 1159168
  buffer_load_dwordx4 v[32:35], v76, s[56:59], s79 offen sc1
  s_mov_b32 s79, 1214464
  buffer_load_dwordx4 v[36:39], v76, s[56:59], s79 offen sc1
  s_mul_i32 s79, s91, 205
  s_lshr_b32 s93, s79, 13
  s_mul_i32 s79, s93, 40
  s_sub_u32 s94, s91, s79
  v_and_b32 v16, 7, v1
  v_lshrrev_b32 v17, 5, v1
  v_lshl_add_u32 v16, v16, 1, v17
  s_lshl_b32 s79, s94, 4
  s_mul_i32 s81, s93, 640
  s_add_u32 s79, s79, s81
  v_add_lshl_u32 v7, v16, s79, 1
  buffer_load_ushort v9, v7, s[60:63], 0 offen
  s_call_b64 s[82:83], L_vbody
  v_mov_b32 v14, v108
  v_mov_b32 v15, v109
  v_and_b32 v77, 7, v1
  v_lshlrev_b32 v77, 4, v77
  v_mov_b32 v57, 0
  s_lshl_b32 s79, s76, 7
  s_add_u32 s79, s79, 1269760
  buffer_load_dwordx4 v[56:59], v77, s[56:59], s79 offen sc1
  s_mov_b32 s90, 0
L_sp1:
  v_xor_b32 v25, s68, v25
  v_xor_b32 v27, s69, v27
  v_or_b32 v16, v25, v27
  v_xor_b32 v29, s68, v29
  v_xor_b32 v31, s69, v31
  v_or3_b32 v16, v16, v29, v31
  v_xor_b32 v33, s68, v33
  v_xor_b32 v35, s69, v35
  v_or3_b32 v16, v16, v33, v35
  v_xor_b32 v37, s68, v37
  v_xor_b32 v39, s69, v39
  v_or3_b32 v16, v16, v37, v39
  v_cmp_ne_u32 vcc, 0, v16
  s_nop 1
  s_and_b64 vcc, vcc, s[70:71]
  s_nop 4
  s_cbranch_vccz L_spd1
  s_add_u32 s90, s90, 1
  s_cmp_ge_u32 s90, 100000
  s_cbranch_scc1 L_spd1
  s_sleep 2
  s_mov_b32 s79, 1048576
  buffer_load_dwordx4 v[24:27], v76, s[56:59], s79 offen sc1
  s_mov_b32 s79, 1103872
  buffer_load_dwordx4 v[28:31], v76, s[56:59], s79 offen sc1
  s_mov_b32 s79, 1159168
  buffer_load_dwordx4 v[32:35], v76, s[56:59], s79 offen sc1
  s_mov_b32 s79, 1214464
  buffer_load_dwordx4 v[36:39], v76, s[56:59], s79 offen sc1
  s_waitcnt vmcnt(0)
  s_branch L_sp1
L_spd1:
  v_cmp_eq_u32 vcc, 1, v78
  s_nop 1
  v_cndmask_b32 v24, v24, v26, vcc
  v_cndmask_b32 v28, v28, v30, vcc
  v_cndmask_b32 v32, v32, v34, vcc
  v_cndmask_b32 v36, v36, v38, vcc
  v_add_f32 v16, v24, v32
  v_add_f32 v17, v28, v36
  v_cvt_pk_bf16_f32 v19, v16, v16
  v_and_b32 v16, 0xffff0000, v19
  v_cvt_pk_bf16_f32 v19, v17, v17
  v_and_b32 v17, 0xffff0000, v19
  v_mul_f32 v18, v16, v16
  v_mul_f32 v18, 0x3d372713, v18
  v_add_f32 v18, 1.0, v18
  v_mul_f32 v18, v18, v16
  v_mul_f32 v18, 0xc0135761, v18
  v_exp_f32 v18, v18
  s_nop 0
  v_add_f32 v18, 1.0, v18
  v_rcp_f32 v18, v18
  s_nop 0
  v_mul_f32 v18, v18, v16
  v_cvt_pk_bf16_f32 v19, v18, v18
  v_and_b32 v18, 0xffff0000, v19
  v_mul_f32 v18, v18, v17
  v_cvt_pk_bf16_f32 v18, v18, v18
  v_cmp_gt_u32 vcc, 8, v2
  s_nop 1
  v_cndmask_b32 v92, 0, v96, vcc
  v_cndmask_b32 v93, 0, v97, vcc
  v_cndmask_b32 v94, 0, v98, vcc
  v_cndmask_b32 v95, 0, v99, vcc
  v_and_b32_dpp v84, v18, v92 row_newbcast:0 row_mask:0xf bank_mask:0xf
  v_and_b32_dpp v85, v18, v93 row_newbcast:0 row_mask:0xf bank_mask:0xf
  v_and_b32_dpp v86, v18, v94 row_newbcast:0 row_mask:0xf bank_mask:0xf
  v_and_b32_dpp v87, v18, v95 row_newbcast:0 row_mask:0xf bank_mask:0xf
  v_and_b32_dpp v88, v18, v92 row_newbcast:1 row_mask:0xf bank_mask:0xf
  v_and_b32_dpp v89, v18, v93 row_newbcast:1 row_mask:0xf bank_mask:0xf
  v_and_b32_dpp v90, v18, v94 row_newbcast:1 row_mask:0xf bank_mask:0xf
  v_and_b32_dpp v91, v18, v95 row_newbcast:1 row_mask:0xf bank_mask:0xf
  s_nop 1
  v_mfma_f32_16x16x32_bf16 a[200:203], v[84:87], a[160:163], 0
  v_mfma_f32_16x16x32_bf16 a[204:207], v[84:87], a[164:167], 0
  v_mfma_f32_16x16x32_bf16 a[208:211], v[84:87], a[168:171], 0
  v_mfma_f32_16x16x32_bf16 a[212:215], v[84:87], a[172:175], 0
  v_mfma_f32_16x16x32_bf16 a[216:219], v[84:87], a[176:179], 0
  v_mfma_f32_16x16x32_bf16 a[200:203], v[88:91], a[180:183], a[200:203]
  v_mfma_f32_16x16x32_bf16 a[204:207], v[88:91], a[184:187], a[204:207]
  v_mfma_f32_16x16x32_bf16 a[208:211], v[88:91], a[188:191], a[208:211]
  v_mfma_f32_16x16x32_bf16 a[212:215], v[88:91], a[192:195], a[212:215]
  v_mfma_f32_16x16x32_bf16 a[216:219], v[88:91], a[196:199], a[216:219]
  v_lshlrev_b32 v9, 16, v9
  s_call_b64 s[82:83], L_vbody
  v_mov_b32 v14, v110
  v_mov_b32 v15, v111
  s_mov_b32 s90, 0
L_sp2:
  v_xor_b32 v16, s68, v57
  v_xor_b32 v17, s69, v59
  v_or_b32 v16, v16, v17
  v_cmp_ne_u32 vcc, 0, v16
  s_nop 4
  s_cbranch_vccz L_spd2
  s_add_u32 s90, s90, 1
  s_cmp_ge_u32 s90, 100000
  s_cbranch_scc1 L_spd2
  s_sleep 2
  s_lshl_b32 s79, s76, 7
  s_add_u32 s79, s79, 1269760
  buffer_load_dwordx4 v[56:59], v77, s[56:59], s79 offen sc1
  s_waitcnt vmcnt(0)
  s_branch L_sp2
L_spd2:
  v_mov_b32 v20, v56
  v_and_b32 v60, 1, v3
  v_lshlrev_b32 v60, 2, v60
  v_max_f32_dpp v20, v20, v20 quad_perm:[1,0,3,2] row_mask:0xf bank_mask:0xf
  v_lshl_add_u32 v62, v2, 3, v60
  s_lshl_b32 s79, s72, 7
  v_max_f32_dpp v20, v20, v20 quad_perm:[2,3,0,1] row_mask:0xf bank_mask:0xf
  v_add_lshl_u32 v60, v62, s79, 2
  v_and_b32 v61, 7, v2
  v_max_f32_dpp v20, v20, v20 row_half_mirror row_mask:0xf bank_mask:0xf
  v_lshl_add_u32 v61, v61, 2, v3
  s_lshl_b32 s79, s72, 5
  v_sub_f32 v56, v56, v20
  v_add_lshl_u32 v61, v61, s79, 2
  v_mul_f32 v56, 0x3fb8aa3b, v56
  v_exp_f32 v56, v56
  v_lshrrev_b32 v21, 1, v3
  s_lshl_b32 s79, s72, 1
  v_mul_f32 v58, v58, v56
  v_add_u32 v21, s79, v21
  v_mul_u32_u24 v21, 640, v21
  v_add_f32_dpp v58, v58, v58 quad_perm:[1,0,3,2] row_mask:0xf bank_mask:0xf
  v_add_lshl_u32 v62, v62, v21, 2
  v_lshlrev_b32 v63, 3, v0
  v_add_f32_dpp v58, v58, v58 quad_perm:[2,3,0,1] row_mask:0xf bank_mask:0xf
  v_lshlrev_b32 v64, 4, v0
  v_lshrrev_b32 v65, 3, v1
  v_add_f32_dpp v58, v58, v58 row_half_mirror row_mask:0xf bank_mask:0xf
  v_sub_f32 v10, v11, v20
  v_mul_f32 v10, 0x3fb8aa3b, v10
  v_exp_f32 v10, v10
  v_rcp_f32 v58, v58
  v_mul_u32_u24 v65, 5120, v65
  v_mul_f32 v10, v10, v58
  v_and_b32 v21, 7, v1
  v_lshl_add_u32 v65, v21, 4, v65
  s_mul_i32 s4, s91, 5120
  s_add_u32 s4, s4, 1286144
  s_mul_i32 s5, s93, 327680
  s_lshl_b32 s81, s94, 7
  s_add_u32 s5, s5, s81
  s_add_u32 s5, s5, 1286144
  buffer_load_ushort v66, v7, s[64:67], 0 offen
  s_call_b64 s[82:83], L_vdrain
  s_nop 7
  v_mul_f32 v80, v80, v10
  v_mul_f32 v81, v81, v10
  v_mul_f32 v82, v82, v10
  v_mul_f32 v83, v83, v10
  s_mov_b32 exec_hi, 0
  ds_write_b128 v60, v[80:83] offset:28672
  s_mov_b32 exec_hi, -1
  s_waitcnt lgkmcnt(0)
  s_barrier
  ds_read_b32 v20, v61 offset:28672
  ds_read_b32 v21, v61 offset:29184
  ds_read_b32 v22, v61 offset:29696
  ds_read_b32 v23, v61 offset:30208
  s_waitcnt lgkmcnt(0)
  v_add_f32 v20, v20, v21
  v_add_f32 v22, v22, v23
  v_add_f32 v20, v20, v22
  v_cvt_pk_bf16_f32 v24, v20, v20
  v_and_b32 v21, 0xffff0000, v24
  v_sub_f32 v21, v20, v21
  v_cvt_pk_bf16_f32 v25, v21, v21
  s_nop 1
  v_and_b32_dpp v84, v24, v96 row_newbcast:0 row_mask:0xf bank_mask:0x3
  v_and_b32_dpp v84, v25, v96 row_newbcast:0 row_mask:0xf bank_mask:0xc
  v_and_b32_dpp v85, v24, v97 row_newbcast:0 row_mask:0xf bank_mask:0x3
  v_and_b32_dpp v85, v25, v97 row_newbcast:0 row_mask:0xf bank_mask:0xc
  v_and_b32_dpp v86, v24, v98 row_newbcast:0 row_mask:0xf bank_mask:0x3
  v_and_b32_dpp v86, v25, v98 row_newbcast:0 row_mask:0xf bank_mask:0xc
  v_and_b32_dpp v87, v24, v99 row_newbcast:0 row_mask:0xf bank_mask:0x3
  v_and_b32_dpp v87, v25, v99 row_newbcast:0 row_mask:0xf bank_mask:0xc
  v_and_b32_dpp v88, v24, v96 row_newbcast:1 row_mask:0xf bank_mask:0x3
  v_and_b32_dpp v88, v25, v96 row_newbcast:1 row_mask:0xf bank_mask:0xc
  v_and_b32_dpp v89, v24, v97 row_newbcast:1 row_mask:0xf bank_mask:0x3
  v_and_b32_dpp v89, v25, v97 row_newbcast:1 row_mask:0xf bank_mask:0xc
  v_and_b32_dpp v90, v24, v98 row_newbcast:1 row_mask:0xf bank_mask:0x3
  v_and_b32_dpp v90, v25, v98 row_newbcast:1 row_mask:0xf bank_mask:0xc
  v_and_b32_dpp v91, v24, v99 row_newbcast:1 row_mask:0xf bank_mask:0x3
  v_and_b32_dpp v91, v25, v99 row_newbcast:1 row_mask:0xf bank_mask:0xc
  v_mfma_f32_16x16x32_bf16 a[200:203], v[84:87], a[0:3], a[200:203]
  v_mfma_f32_16x16x32_bf16 a[204:207], v[84:87], a[4:7], a[204:207]
  v_mfma_f32_16x16x32_bf16 a[208:211], v[84:87], a[8:11], a[208:211]
  v_mfma_f32_16x16x32_bf16 a[212:215], v[84:87], a[12:15], a[212:215]
  v_mfma_f32_16x16x32_bf16 a[216:219], v[84:87], a[16:19], a[216:219]
  v_and_b32_dpp v84, v24, v96 row_newbcast:2 row_mask:0xf bank_mask:0x3
  v_and_b32_dpp v84, v25, v96 row_newbcast:2 row_mask:0xf bank_mask:0xc
  v_and_b32_dpp v85, v24, v97 row_newbcast:2 row_mask:0xf bank_mask:0x3
  v_and_b32_dpp v85, v25, v97 row_newbcast:2 row_mask:0xf bank_mask:0xc
  v_and_b32_dpp v86, v24, v98 row_newbcast:2 row_mask:0xf bank_mask:0x3
  v_and_b32_dpp v86, v25, v98 row_newbcast:2 row_mask:0xf bank_mask:0xc
  v_and_b32_dpp v87, v24, v99 row_newbcast:2 row_mask:0xf bank_mask:0x3
  v_and_b32_dpp v87, v25, v99 row_newbcast:2 row_mask:0xf bank_mask:0xc
  v_mfma_f32_16x16x32_bf16 a[200:203], v[88:91], a[20:23], a[200:203]
  v_mfma_f32_16x16x32_bf16 a[204:207], v[88:91], a[24:27], a[204:207]
  v_mfma_f32_16x16x32_bf16 a[208:211], v[88:91], a[28:31], a[208:211]
  v_mfma_f32_16x16x32_bf16 a[212:215], v[88:91], a[32:35], a[212:215]
  v_mfma_f32_16x16x32_bf16 a[216:219], v[88:91], a[36:39], a[216:219]
  v_and_b32_dpp v88, v24, v96 row_newbcast:3 row_mask:0xf bank_mask:0x3
  v_and_b32_dpp v88, v25, v96 row_newbcast:3 row_mask:0xf bank_mask:0xc
  v_and_b32_dpp v89, v24, v97 row_newbcast:3 row_mask:0xf bank_mask:0x3
  v_and_b32_dpp v89, v25, v97 row_newbcast:3 row_mask:0xf bank_mask:0xc
  v_and_b32_dpp v90, v24, v98 row_newbcast:3 row_mask:0xf bank_mask:0x3
  v_and_b32_dpp v90, v25, v98 row_newbcast:3 row_mask:0xf bank_mask:0xc
  v_and_b32_dpp v91, v24, v99 row_newbcast:3 row_mask:0xf bank_mask:0x3
  v_and_b32_dpp v91, v25, v99 row_newbcast:3 row_mask:0xf bank_mask:0xc
  v_mfma_f32_16x16x32_bf16 a[200:203], v[84:87], a[40:43], a[200:203]
  v_mfma_f32_16x16x32_bf16 a[204:207], v[84:87], a[44:47], a[204:207]
  v_mfma_f32_16x16x32_bf16 a[208:211], v[84:87], a[48:51], a[208:211]
  v_mfma_f32_16x16x32_bf16 a[212:215], v[84:87], a[52:55], a[212:215]
  v_mfma_f32_16x16x32_bf16 a[216:219], v[84:87], a[56:59], a[216:219]
  v_and_b32_dpp v84, v24, v96 row_newbcast:4 row_mask:0xf bank_mask:0x3
  v_and_b32_dpp v84, v25, v96 row_newbcast:4 row_mask:0xf bank_mask:0xc
  v_and_b32_dpp v85, v24, v97 row_newbcast:4 row_mask:0xf bank_mask:0x3
  v_and_b32_dpp v85, v25, v97 row_newbcast:4 row_mask:0xf bank_mask:0xc
  v_and_b32_dpp v86, v24, v98 row_newbcast:4 row_mask:0xf bank_mask:0x3
  v_and_b32_dpp v86, v25, v98 row_newbcast:4 row_mask:0xf bank_mask:0xc
  v_and_b32_dpp v87, v24, v99 row_newbcast:4 row_mask:0xf bank_mask:0x3
  v_and_b32_dpp v87, v25, v99 row_newbcast:4 row_mask:0xf bank_mask:0xc
  v_mfma_f32_16x16x32_bf16 a[200:203], v[88:91], a[60:63], a[200:203]
  v_mfma_f32_16x16x32_bf16 a[204:207], v[88:91], a[64:67], a[204:207]
  v_mfma_f32_16x16x32_bf16 a[208:211], v[88:91], a[68:71], a[208:211]
  v_mfma_f32_16x16x32_bf16 a[212:215], v[88:91], a[72:75], a[212:215]
  v_mfma_f32_16x16x32_bf16 a[216:219], v[88:91], a[76:79], a[216:219]
  v_and_b32_dpp v88, v24, v96 row_newbcast:5 row_mask:0xf bank_mask:0x3
  v_and_b32_dpp v88, v25, v96 row_newbcast:5 row_mask:0xf bank_mask:0xc
  v_and_b32_dpp v89, v24, v97 row_newbcast:5 row_mask:0xf bank_mask:0x3
  v_and_b32_dpp v89, v25, v97 row_newbcast:5 row_mask:0xf bank_mask:0xc
  v_and_b32_dpp v90, v24, v98 row_newbcast:5 row_mask:0xf bank_mask:0x3
  v_and_b32_dpp v90, v25, v98 row_newbcast:5 row_mask:0xf bank_mask:0xc
  v_and_b32_dpp v91, v24, v99 row_newbcast:5 row_mask:0xf bank_mask:0x3
  v_and_b32_dpp v91, v25, v99 row_newbcast:5 row_mask:0xf bank_mask:0xc
  v_mfma_f32_16x16x32_bf16 a[200:203], v[84:87], a[80:83], a[200:203]
  v_mfma_f32_16x16x32_bf16 a[204:207], v[84:87], a[84:87], a[204:207]
  v_mfma_f32_16x16x32_bf16 a[208:211], v[84:87], a[88:91], a[208:211]
  v_mfma_f32_16x16x32_bf16 a[212:215], v[84:87], a[92:95], a[212:215]
  v_mfma_f32_16x16x32_bf16 a[216:219], v[84:87], a[96:99], a[216:219]
  v_and_b32_dpp v84, v24, v96 row_newbcast:6 row_mask:0xf bank_mask:0x3
  v_and_b32_dpp v84, v25, v96 row_newbcast:6 row_mask:0xf bank_mask:0xc
  v_and_b32_dpp v85, v24, v97 row_newbcast:6 row_mask:0xf bank_mask:0x3
  v_and_b32_dpp v85, v25, v97 row_newbcast:6 row_mask:0xf bank_mask:0xc
  v_and_b32_dpp v86, v24, v98 row_newbcast:6 row_mask:0xf bank_mask:0x3
  v_and_b32_dpp v86, v25, v98 row_newbcast:6 row_mask:0xf bank_mask:0xc
  v_and_b32_dpp v87, v24, v99 row_newbcast:6 row_mask:0xf bank_mask:0x3
  v_and_b32_dpp v87, v25, v99 row_newbcast:6 row_mask:0xf bank_mask:0xc
  v_mfma_f32_16x16x32_bf16 a[200:203], v[88:91], a[100:103], a[200:203]
  v_mfma_f32_16x16x32_bf16 a[204:207], v[88:91], a[104:107], a[204:207]
  v_mfma_f32_16x16x32_bf16 a[208:211], v[88:91], a[108:111], a[208:211]
  v_mfma_f32_16x16x32_bf16 a[212:215], v[88:91], a[112:115], a[212:215]
  v_mfma_f32_16x16x32_bf16 a[216:219], v[88:91], a[116:119], a[216:219]
  v_and_b32_dpp v88, v24, v96 row_newbcast:7 row_mask:0xf bank_mask:0x3
  v_and_b32_dpp v88, v25, v96 row_newbcast:7 row_mask:0xf bank_mask:0xc
  v_and_b32_dpp v89, v24, v97 row_newbcast:7 row_mask:0xf bank_mask:0x3
  v_and_b32_dpp v89, v25, v97 row_newbcast:7 row_mask:0xf bank_mask:0xc
  v_and_b32_dpp v90, v24, v98 row_newbcast:7 row_mask:0xf bank_mask:0x3
  v_and_b32_dpp v90, v25, v98 row_newbcast:7 row_mask:0xf bank_mask:0xc
  v_and_b32_dpp v91, v24, v99 row_newbcast:7 row_mask:0xf bank_mask:0x3
  v_and_b32_dpp v91, v25, v99 row_newbcast:7 row_mask:0xf bank_mask:0xc
  v_mfma_f32_16x16x32_bf16 a[200:203], v[84:87], a[120:123], a[200:203]
  v_mfma_f32_16x16x32_bf16 a[204:207], v[84:87], a[124:127], a[204:207]
  v_mfma_f32_16x16x32_bf16 a[208:211], v[84:87], a[128:131], a[208:211]
  v_mfma_f32_16x16x32_bf16 a[212:215], v[84:87], a[132:135], a[212:215]
  v_mfma_f32_16x16x32_bf16 a[216:219], v[84:87], a[136:139], a[216:219]
  v_mfma_f32_16x16x32_bf16 a[200:203], v[88:91], a[140:143], a[200:203]
  v_mfma_f32_16x16x32_bf16 a[204:207], v[88:91], a[144:147], a[204:207]
  v_mfma_f32_16x16x32_bf16 a[208:211], v[88:91], a[148:151], a[208:211]
  v_mfma_f32_16x16x32_bf16 a[212:215], v[88:91], a[152:155], a[212:215]
  v_mfma_f32_16x16x32_bf16 a[216:219], v[88:91], a[156:159], a[216:219]
  s_nop 3
  ds_write_b128 v62, a[200:203] offset:30720
  ds_write_b128 v62, a[204:207] offset:31232
  ds_write_b128 v62, a[208:211] offset:31744
  ds_write_b128 v62, a[212:215] offset:32256
  s_nop 0
  ds_write_b128 v62, a[216:219] offset:32768
  s_waitcnt lgkmcnt(0)
  s_barrier
  s_cmp_eq_u32 s72, 3
  s_cbranch_scc1 L_cons
  ds_read_b64 v[20:21], v63 offset:30720
  ds_read_b64 v[22:23], v63 offset:33280
  ds_read_b64 v[24:25], v63 offset:35840
  ds_read_b64 v[26:27], v63 offset:38400
  ds_read_b64 v[28:29], v63 offset:40960
  ds_read_b64 v[30:31], v63 offset:43520
  ds_read_b64 v[32:33], v63 offset:46080
  ds_read_b64 v[34:35], v63 offset:48640
  s_cmp_eq_u32 s72, 2
  s_cbranch_scc1 L_y1
  ds_read_b64 v[40:41], v63 offset:32256
  ds_read_b64 v[42:43], v63 offset:34816
  ds_read_b64 v[44:45], v63 offset:37376
  ds_read_b64 v[46:47], v63 offset:39936
  ds_read_b64 v[48:49], v63 offset:42496
  ds_read_b64 v[50:51], v63 offset:45056
  ds_read_b64 v[52:53], v63 offset:47616
  ds_read_b64 v[54:55], v63 offset:50176
L_y1:
  v_mov_b32 v69, s68
  v_mov_b32 v71, s69
  v_mov_b32 v57, s68
  v_mov_b32 v59, s69
  s_waitcnt lgkmcnt(0)
  v_add_f32 v20, v20, v22
  v_add_f32 v24, v24, v26
  v_add_f32 v28, v28, v30
  v_add_f32 v32, v32, v34
  v_add_f32 v21, v21, v23
  v_add_f32 v25, v25, v27
  v_add_f32 v29, v29, v31
  v_add_f32 v33, v33, v35
  v_add_f32 v20, v20, v24
  v_add_f32 v28, v28, v32
  v_add_f32 v21, v21, v25
  v_add_f32 v29, v29, v33
  v_add_f32 v68, v20, v28
  v_add_f32 v70, v21, v29
  buffer_store_dwordx4 v[68:71], v64, s[56:59], s4 offen sc1
  s_cmp_eq_u32 s72, 2
  s_cbranch_scc1 L_y2
  v_add_f32 v40, v40, v42
  v_add_f32 v44, v44, v46
  v_add_f32 v48, v48, v50
  v_add_f32 v52, v52, v54
  v_add_f32 v41, v41, v43
  v_add_f32 v45, v45, v47
  v_add_f32 v49, v49, v51
  v_add_f32 v53, v53, v55
  v_add_f32 v40, v40, v44
  v_add_f32 v48, v48, v52
  v_add_f32 v41, v41, v45
  v_add_f32 v49, v49, v53
  v_add_f32 v56, v40, v48
  v_add_f32 v58, v41, v49
  buffer_store_dwordx4 v[56:59], v64, s[56:59], s4 offen offset:3072 sc1
L_y2:
  s_endpgm
L_cons:
  s_cmp_lt_u32 s91, 160
  s_cbranch_scc0 L_end
  s_mov_b32 s90, 0
  s_mov_b32 s79, s5
  buffer_load_dwordx4 v[128:131], v65, s[56:59], s79 offen sc1
  s_add_u32 s79, s79, 40960
  buffer_load_dwordx4 v[132:135], v65, s[56:59], s79 offen sc1
  s_add_u32 s79, s79, 40960
  buffer_load_dwordx4 v[136:139], v65, s[56:59], s79 offen sc1
  s_add_u32 s79, s79, 40960
  buffer_load_dwordx4 v[140:143], v65, s[56:59], s79 offen sc1
  s_add_u32 s79, s79, 40960
  buffer_load_dwordx4 v[144:147], v65, s[56:59], s79 offen sc1
  s_add_u32 s79, s79, 40960
  buffer_load_dwordx4 v[148:151], v65, s[56:59], s79 offen sc1
  s_add_u32 s79, s79, 40960
  buffer_load_dwordx4 v[152:155], v65, s[56:59], s79 offen sc1
  s_add_u32 s79, s79, 40960
  buffer_load_dwordx4 v[156:159], v65, s[56:59], s79 offen sc1
  s_mov_b32 s79, s5
  buffer_load_dwordx4 v[160:163], v65, s[56:59], s79 offen sc1
  s_add_u32 s79, s79, 40960
  buffer_load_dwordx4 v[164:167], v65, s[56:59], s79 offen sc1
  s_add_u32 s79, s79, 40960
  buffer_load_dwordx4 v[168:171], v65, s[56:59], s79 offen sc1
  s_add_u32 s79, s79, 40960
  buffer_load_dwordx4 v[172:175], v65, s[56:59], s79 offen sc1
  s_add_u32 s79, s79, 40960
  buffer_load_dwordx4 v[176:179], v65, s[56:59], s79 offen sc1
  s_add_u32 s79, s79, 40960
  buffer_load_dwordx4 v[180:183], v65, s[56:59], s79 offen sc1
  s_add_u32 s79, s79, 40960
  buffer_load_dwordx4 v[184:187], v65, s[56:59], s79 offen sc1
  s_add_u32 s79, s79, 40960
  buffer_load_dwordx4 v[188:191], v65, s[56:59], s79 offen sc1
L_cp:
  s_waitcnt vmcnt(8)
  v_xor_b32 v129, s68, v129
  v_xor_b32 v131, s69, v131
  v_or_b32 v17, v129, v131
  v_xor_b32 v133, s68, v133
  v_xor_b32 v135, s69, v135
  v_or3_b32 v17, v17, v133, v135
  v_xor_b32 v137, s68, v137
  v_xor_b32 v139, s69, v139
  v_or3_b32 v17, v17, v137, v139
  v_xor_b32 v141, s68, v141
  v_xor_b32 v143, s69, v143
  v_or3_b32 v17, v17, v141, v143
  v_xor_b32 v145, s68, v145
  v_xor_b32 v147, s69, v147
  v_or3_b32 v17, v17, v145, v147
  v_xor_b32 v149, s68, v149
  v_xor_b32 v151, s69, v151
  v_or3_b32 v17, v17, v149, v151
  v_xor_b32 v153, s68, v153
  v_xor_b32 v155, s69, v155
  v_or3_b32 v17, v17, v153, v155
  v_xor_b32 v157, s68, v157
  v_xor_b32 v159, s69, v159
  v_or3_b32 v17, v17, v157, v159
  v_cmp_ne_u32 vcc, 0, v17
  s_nop 4
  s_cbranch_vccz L_cA
  s_mov_b32 s79, s5
  buffer_load_dwordx4 v[128:131], v65, s[56:59], s79 offen sc1
  s_add_u32 s79, s79, 40960
  buffer_load_dwordx4 v[132:135], v65, s[56:59], s79 offen sc1
  s_add_u32 s79, s79, 40960
  buffer_load_dwordx4 v[136:139], v65, s[56:59], s79 offen sc1
  s_add_u32 s79, s79, 40960
  buffer_load_dwordx4 v[140:143], v65, s[56:59], s79 offen sc1
  s_add_u32 s79, s79, 40960
  buffer_load_dwordx4 v[144:147], v65, s[56:59], s79 offen sc1
  s_add_u32 s79, s79, 40960
  buffer_load_dwordx4 v[148:151], v65, s[56:59], s79 offen sc1
  s_add_u32 s79, s79, 40960
  buffer_load_dwordx4 v[152:155], v65, s[56:59], s79 offen sc1
  s_add_u32 s79, s79, 40960
  buffer_load_dwordx4 v[156:159], v65, s[56:59], s79 offen sc1
  s_waitcnt vmcnt(8)
  v_xor_b32 v161, s68, v161
  v_xor_b32 v163, s69, v163
  v_or_b32 v17, v161, v163
  v_xor_b32 v165, s68, v165
  v_xor_b32 v167, s69, v167
  v_or3_b32 v17, v17, v165, v167
  v_xor_b32 v169, s68, v169
  v_xor_b32 v171, s69, v171
  v_or3_b32 v17, v17, v169, v171
  v_xor_b32 v173, s68, v173
  v_xor_b32 v175, s69, v175
  v_or3_b32 v17, v17, v173, v175
  v_xor_b32 v177, s68, v177
  v_xor_b32 v179, s69, v179
  v_or3_b32 v17, v17, v177, v179
  v_xor_b32 v181, s68, v181
  v_xor_b32 v183, s69, v183
  v_or3_b32 v17, v17, v181, v183
  v_xor_b32 v185, s68, v185
  v_xor_b32 v187, s69, v187
  v_or3_b32 v17, v17, v185, v187
  v_xor_b32 v189, s68, v189
  v_xor_b32 v191, s69, v191
  v_or3_b32 v17, v17, v189, v191
  v_cmp_ne_u32 vcc, 0, v17
  s_nop 4
  s_cbranch_vccz L_cB
  s_mov_b32 s79, s5
  buffer_load_dwordx4 v[160:163], v65, s[56:59], s79 offen sc1
  s_add_u32 s79, s79, 40960
  buffer_load_dwordx4 v[164:167], v65, s[56:59], s79 offen sc1
  s_add_u32 s79, s79, 40960
  buffer_load_dwordx4 v[168:171], v65, s[56:59], s79 offen sc1
  s_add_u32 s79, s79, 40960
  buffer_load_dwordx4 v[172:175], v65, s[56:59], s79 offen sc1
  s_add_u32 s79, s79, 40960
  buffer_load_dwordx4 v[176:179], v65, s[56:59], s79 offen sc1
  s_add_u32 s79, s79, 40960
  buffer_load_dwordx4 v[180:183], v65, s[56:59], s79 offen sc1
  s_add_u32 s79, s79, 40960
  buffer_load_dwordx4 v[184:187], v65, s[56:59], s79 offen sc1
  s_add_u32 s79, s79, 40960
  buffer_load_dwordx4 v[188:191], v65, s[56:59], s79 offen sc1
  s_add_u32 s90, s90, 1
  s_cmp_lt_u32 s90, 100000
  s_cbranch_scc1 L_cp
L_cA:
  v_add_f32 v128, v128, v132
  v_add_f32 v130, v130, v134
  v_add_f32 v136, v136, v140
  v_add_f32 v138, v138, v142
  v_add_f32 v144, v144, v148
  v_add_f32 v146, v146, v150
  v_add_f32 v152, v152, v156
  v_add_f32 v154, v154, v158
  v_add_f32 v128, v128, v136
  v_add_f32 v130, v130, v138
  v_add_f32 v144, v144, v152
  v_add_f32 v146, v146, v154
  v_add_f32 v20, v128, v144
  v_add_f32 v21, v130, v146
  s_branch L_cfin
L_cB:
  v_add_f32 v160, v160, v164
  v_add_f32 v162, v162, v166
  v_add_f32 v168, v168, v172
  v_add_f32 v170, v170, v174
  v_add_f32 v176, v176, v180
  v_add_f32 v178, v178, v182
  v_add_f32 v184, v184, v188
  v_add_f32 v186, v186, v190
  v_add_f32 v160, v160, v168
  v_add_f32 v162, v162, v170
  v_add_f32 v176, v176, v184
  v_add_f32 v178, v178, v186
  v_add_f32 v20, v160, v176
  v_add_f32 v21, v162, v178
L_cfin:
  s_nop 1
  v_permlane32_swap_b32 v20, v21
  s_nop 1
  v_add_f32 v20, v20, v21
  v_mov_b32 v21, v20
  s_nop 1
  v_permlane16_swap_b32 v20, v21
  s_nop 1
  v_add_f32 v20, v20, v21
  s_nop 1
  v_add_f32_dpp v20, v20, v20 row_ror:8 row_mask:0xf bank_mask:0xf
  v_add_f32 v20, v20, v9
  v_cvt_pk_bf16_f32 v20, v20, v20
  s_mov_b32 exec_lo, 0xff
  s_mov_b32 exec_hi, 0xff
  buffer_store_short v20, v7, s[64:67], 0 offen
  s_cmp_eq_u32 s91, 0
  s_cbranch_scc0 L_noep
  v_mov_b32 v18, s68
  v_mov_b32 v19, s69
  v_mov_b32 v17, 0
  s_mov_b32 s79, 2596864
  s_mov_b64 exec, 1
  buffer_store_dwordx2 v[18:19], v17, s[56:59], s79 offen sc1
L_noep:
L_end:
  s_endpgm
.p2align 6
L_kbody:
  s_waitcnt vmcnt(31)
  v_dot2_f32_bf16 v112, v128, v100, 0
  v_dot2_f32_bf16 v112, v129, v101, v112
  v_dot2_f32_bf16 v112, v130, v102, v112
  v_dot2_f32_bf16 v112, v131, v103, v112
  buffer_load_dwordx4 v[128:131], v4, s[36:39], s77 offen nt
  s_add_u32 s77, s77, 4096
  s_waitcnt vmcnt(31)
  v_dot2_f32_bf16 v113, v132, v100, 0
  v_dot2_f32_bf16 v113, v133, v101, v113
  v_dot2_f32_bf16 v113, v134, v102, v113
  v_dot2_f32_bf16 v113, v135, v103, v113
  buffer_load_dwordx4 v[132:135], v4, s[36:39], s77 offen nt
  s_add_u32 s77, s77, 4096
  s_waitcnt vmcnt(31)
  v_dot2_f32_bf16 v114, v136, v100, 0
  v_dot2_f32_bf16 v114, v137, v101, v114
  v_dot2_f32_bf16 v114, v138, v102, v114
  v_dot2_f32_bf16 v114, v139, v103, v114
  buffer_load_dwordx4 v[136:139], v4, s[36:39], s77 offen nt
  s_add_u32 s77, s77, 4096
  s_waitcnt vmcnt(31)
  v_dot2_f32_bf16 v115, v140, v100, 0
  v_dot2_f32_bf16 v115, v141, v101, v115
  v_dot2_f32_bf16 v115, v142, v102, v115
  v_dot2_f32_bf16 v115, v143, v103, v115
  buffer_load_dwordx4 v[140:143], v4, s[36:39], s77 offen nt
  s_add_u32 s77, s77, 4096
  s_waitcnt vmcnt(31)
  v_dot2_f32_bf16 v116, v144, v100, 0
  v_dot2_f32_bf16 v116, v145, v101, v116
  v_dot2_f32_bf16 v116, v146, v102, v116
  v_dot2_f32_bf16 v116, v147, v103, v116
  buffer_load_dwordx4 v[144:147], v4, s[36:39], s77 offen nt
  s_add_u32 s77, s77, 4096
  s_waitcnt vmcnt(31)
  v_dot2_f32_bf16 v117, v148, v100, 0
  v_dot2_f32_bf16 v117, v149, v101, v117
  v_dot2_f32_bf16 v117, v150, v102, v117
  v_dot2_f32_bf16 v117, v151, v103, v117
  buffer_load_dwordx4 v[148:151], v4, s[36:39], s77 offen nt
  s_add_u32 s77, s77, 4096
  s_waitcnt vmcnt(31)
  v_dot2_f32_bf16 v118, v152, v100, 0
  v_dot2_f32_bf16 v118, v153, v101, v118
  v_dot2_f32_bf16 v118, v154, v102, v118
  v_dot2_f32_bf16 v118, v155, v103, v118
  buffer_load_dwordx4 v[152:155], v4, s[36:39], s77 offen nt
  s_add_u32 s77, s77, 4096
  s_waitcnt vmcnt(31)
  v_dot2_f32_bf16 v119, v156, v100, 0
  v_dot2_f32_bf16 v119, v157, v101, v119
  v_dot2_f32_bf16 v119, v158, v102, v119
  v_dot2_f32_bf16 v119, v159, v103, v119
  buffer_load_dwordx4 v[156:159], v4, s[36:39], s77 offen nt
  s_add_u32 s77, s77, 4096
  s_waitcnt vmcnt(31)
  v_dot2_f32_bf16 v120, v160, v100, 0
  v_dot2_f32_bf16 v120, v161, v101, v120
  v_dot2_f32_bf16 v120, v162, v102, v120
  v_dot2_f32_bf16 v120, v163, v103, v120
  buffer_load_dwordx4 v[160:163], v4, s[36:39], s77 offen nt
  s_add_u32 s77, s77, 4096
  s_waitcnt vmcnt(31)
  v_dot2_f32_bf16 v121, v164, v100, 0
  v_dot2_f32_bf16 v121, v165, v101, v121
  v_dot2_f32_bf16 v121, v166, v102, v121
  v_dot2_f32_bf16 v121, v167, v103, v121
  buffer_load_dwordx4 v[164:167], v4, s[36:39], s77 offen nt
  s_add_u32 s77, s77, 4096
  s_waitcnt vmcnt(31)
  v_dot2_f32_bf16 v122, v168, v100, 0
  v_dot2_f32_bf16 v122, v169, v101, v122
  v_dot2_f32_bf16 v122, v170, v102, v122
  v_dot2_f32_bf16 v122, v171, v103, v122
  buffer_load_dwordx4 v[168:171], v4, s[36:39], s77 offen nt
  s_add_u32 s77, s77, 4096
  s_waitcnt vmcnt(31)
  v_dot2_f32_bf16 v123, v172, v100, 0
  v_dot2_f32_bf16 v123, v173, v101, v123
  v_dot2_f32_bf16 v123, v174, v102, v123
  v_dot2_f32_bf16 v123, v175, v103, v123
  buffer_load_dwordx4 v[172:175], v4, s[36:39], s77 offen nt
  s_add_u32 s77, s77, 4096
  s_waitcnt vmcnt(31)
  v_dot2_f32_bf16 v124, v176, v100, 0
  v_dot2_f32_bf16 v124, v177, v101, v124
  v_dot2_f32_bf16 v124, v178, v102, v124
  v_dot2_f32_bf16 v124, v179, v103, v124
  buffer_load_dwordx4 v[176:179], v4, s[36:39], s77 offen nt
  s_add_u32 s77, s77, 4096
  s_waitcnt vmcnt(31)
  v_dot2_f32_bf16 v125, v180, v100, 0
  v_dot2_f32_bf16 v125, v181, v101, v125
  v_dot2_f32_bf16 v125, v182, v102, v125
  v_dot2_f32_bf16 v125, v183, v103, v125
  buffer_load_dwordx4 v[180:183], v4, s[36:39], s77 offen nt
  s_add_u32 s77, s77, 4096
  s_waitcnt vmcnt(31)
  v_dot2_f32_bf16 v126, v184, v100, 0
  v_dot2_f32_bf16 v126, v185, v101, v126
  v_dot2_f32_bf16 v126, v186, v102, v126
  v_dot2_f32_bf16 v126, v187, v103, v126
  buffer_load_dwordx4 v[184:187], v4, s[36:39], s77 offen nt
  s_add_u32 s77, s77, 4096
  s_waitcnt vmcnt(31)
  v_dot2_f32_bf16 v127, v188, v100, 0
  v_dot2_f32_bf16 v127, v189, v101, v127
  v_dot2_f32_bf16 v127, v190, v102, v127
  v_dot2_f32_bf16 v127, v191, v103, v127
  buffer_load_dwordx4 v[188:191], v4, s[36:39], s77 offen nt
  s_add_u32 s77, s77, 4096
  s_nop 1
  v_add_f32_dpp v112, v112, v112 row_ror:8 row_mask:0xf bank_mask:0x3
  v_add_f32_dpp v112, v120, v120 row_ror:8 row_mask:0xf bank_mask:0xc
  v_add_f32_dpp v113, v113, v113 row_ror:8 row_mask:0xf bank_mask:0x3
  v_add_f32_dpp v113, v121, v121 row_ror:8 row_mask:0xf bank_mask:0xc
  v_add_f32_dpp v114, v114, v114 row_ror:8 row_mask:0xf bank_mask:0x3
  v_add_f32_dpp v114, v122, v122 row_ror:8 row_mask:0xf bank_mask:0xc
  v_add_f32_dpp v115, v115, v115 row_ror:8 row_mask:0xf bank_mask:0x3
  v_add_f32_dpp v115, v123, v123 row_ror:8 row_mask:0xf bank_mask:0xc
  v_add_f32_dpp v116, v116, v116 row_ror:8 row_mask:0xf bank_mask:0x3
  v_add_f32_dpp v116, v124, v124 row_ror:8 row_mask:0xf bank_mask:0xc
  v_add_f32_dpp v117, v117, v117 row_ror:8 row_mask:0xf bank_mask:0x3
  v_add_f32_dpp v117, v125, v125 row_ror:8 row_mask:0xf bank_mask:0xc
  v_add_f32_dpp v118, v118, v118 row_ror:8 row_mask:0xf bank_mask:0x3
  v_add_f32_dpp v118, v126, v126 row_ror:8 row_mask:0xf bank_mask:0xc
  v_add_f32_dpp v119, v119, v119 row_ror:8 row_mask:0xf bank_mask:0x3
  v_add_f32_dpp v119, v127, v127 row_ror:8 row_mask:0xf bank_mask:0xc
  v_add_f32_dpp v112, v112, v112 row_half_mirror row_mask:0xf bank_mask:0x5
  v_add_f32_dpp v112, v116, v116 row_half_mirror row_mask:0xf bank_mask:0xa
  v_add_f32_dpp v113, v113, v113 row_half_mirror row_mask:0xf bank_mask:0x5
  v_add_f32_dpp v113, v117, v117 row_half_mirror row_mask:0xf bank_mask:0xa
  v_add_f32_dpp v114, v114, v114 row_half_mirror row_mask:0xf bank_mask:0x5
  v_add_f32_dpp v114, v118, v118 row_half_mirror row_mask:0xf bank_mask:0xa
  v_add_f32_dpp v115, v115, v115 row_half_mirror row_mask:0xf bank_mask:0x5
  v_add_f32_dpp v115, v119, v119 row_half_mirror row_mask:0xf bank_mask:0xa
  s_nop 1
  v_add_f32_dpp v112, v112, v112 quad_perm:[2,3,0,1] row_mask:0xf bank_mask:0xf
  v_add_f32_dpp v113, v113, v113 quad_perm:[2,3,0,1] row_mask:0xf bank_mask:0xf
  v_add_f32_dpp v114, v114, v114 quad_perm:[2,3,0,1] row_mask:0xf bank_mask:0xf
  v_add_f32_dpp v115, v115, v115 quad_perm:[2,3,0,1] row_mask:0xf bank_mask:0xf
  v_cndmask_b32 v112, v112, v114, s[84:85]
  v_cndmask_b32 v113, v113, v115, s[84:85]
  s_nop 1
  v_add_f32_dpp v112, v112, v112 quad_perm:[1,0,3,2] row_mask:0xf bank_mask:0xf
  v_add_f32_dpp v113, v113, v113 quad_perm:[1,0,3,2] row_mask:0xf bank_mask:0xf
  v_cndmask_b32 v14, v112, v113, s[86:87]
  s_waitcnt vmcnt(31)
  v_dot2_f32_bf16 v112, v192, v100, 0
  v_dot2_f32_bf16 v112, v193, v101, v112
  v_dot2_f32_bf16 v112, v194, v102, v112
  v_dot2_f32_bf16 v112, v195, v103, v112
  buffer_load_dwordx4 v[192:195], v4, s[36:39], s77 offen nt
  s_add_u32 s77, s77, 4096
  s_waitcnt vmcnt(31)
  v_dot2_f32_bf16 v113, v196, v100, 0
  v_dot2_f32_bf16 v113, v197, v101, v113
  v_dot2_f32_bf16 v113, v198, v102, v113
  v_dot2_f32_bf16 v113, v199, v103, v113
  buffer_load_dwordx4 v[196:199], v4, s[36:39], s77 offen nt
  s_add_u32 s77, s77, 4096
  s_waitcnt vmcnt(31)
  v_dot2_f32_bf16 v114, v200, v100, 0
  v_dot2_f32_bf16 v114, v201, v101, v114
  v_dot2_f32_bf16 v114, v202, v102, v114
  v_dot2_f32_bf16 v114, v203, v103, v114
  buffer_load_dwordx4 v[200:203], v4, s[36:39], s77 offen nt
  s_add_u32 s77, s77, 4096
  s_waitcnt vmcnt(31)
  v_dot2_f32_bf16 v115, v204, v100, 0
  v_dot2_f32_bf16 v115, v205, v101, v115
  v_dot2_f32_bf16 v115, v206, v102, v115
  v_dot2_f32_bf16 v115, v207, v103, v115
  buffer_load_dwordx4 v[204:207], v4, s[36:39], s77 offen nt
  s_add_u32 s77, s77, 4096
  s_waitcnt vmcnt(31)
  v_dot2_f32_bf16 v116, v208, v100, 0
  v_dot2_f32_bf16 v116, v209, v101, v116
  v_dot2_f32_bf16 v116, v210, v102, v116
  v_dot2_f32_bf16 v116, v211, v103, v116
  buffer_load_dwordx4 v[208:211], v4, s[36:39], s77 offen nt
  s_add_u32 s77, s77, 4096
  s_waitcnt vmcnt(31)
  v_dot2_f32_bf16 v117, v212, v100, 0
  v_dot2_f32_bf16 v117, v213, v101, v117
  v_dot2_f32_bf16 v117, v214, v102, v117
  v_dot2_f32_bf16 v117, v215, v103, v117
  buffer_load_dwordx4 v[212:215], v4, s[36:39], s77 offen nt
  s_add_u32 s77, s77, 4096
  s_waitcnt vmcnt(31)
  v_dot2_f32_bf16 v118, v216, v100, 0
  v_dot2_f32_bf16 v118, v217, v101, v118
  v_dot2_f32_bf16 v118, v218, v102, v118
  v_dot2_f32_bf16 v118, v219, v103, v118
  buffer_load_dwordx4 v[216:219], v4, s[36:39], s77 offen nt
  s_add_u32 s77, s77, 4096
  s_waitcnt vmcnt(31)
  v_dot2_f32_bf16 v119, v220, v100, 0
  v_dot2_f32_bf16 v119, v221, v101, v119
  v_dot2_f32_bf16 v119, v222, v102, v119
  v_dot2_f32_bf16 v119, v223, v103, v119
  buffer_load_dwordx4 v[220:223], v4, s[36:39], s77 offen nt
  s_add_u32 s77, s77, 4096
  s_waitcnt vmcnt(31)
  v_dot2_f32_bf16 v120, v224, v100, 0
  v_dot2_f32_bf16 v120, v225, v101, v120
  v_dot2_f32_bf16 v120, v226, v102, v120
  v_dot2_f32_bf16 v120, v227, v103, v120
  buffer_load_dwordx4 v[224:227], v4, s[36:39], s77 offen nt
  s_add_u32 s77, s77, 4096
  s_waitcnt vmcnt(31)
  v_dot2_f32_bf16 v121, v228, v100, 0
  v_dot2_f32_bf16 v121, v229, v101, v121
  v_dot2_f32_bf16 v121, v230, v102, v121
  v_dot2_f32_bf16 v121, v231, v103, v121
  buffer_load_dwordx4 v[228:231], v4, s[36:39], s77 offen nt
  s_add_u32 s77, s77, 4096
  s_waitcnt vmcnt(31)
  v_dot2_f32_bf16 v122, v232, v100, 0
  v_dot2_f32_bf16 v122, v233, v101, v122
  v_dot2_f32_bf16 v122, v234, v102, v122
  v_dot2_f32_bf16 v122, v235, v103, v122
  buffer_load_dwordx4 v[232:235], v4, s[36:39], s77 offen nt
  s_add_u32 s77, s77, 4096
  s_waitcnt vmcnt(31)
  v_dot2_f32_bf16 v123, v236, v100, 0
  v_dot2_f32_bf16 v123, v237, v101, v123
  v_dot2_f32_bf16 v123, v238, v102, v123
  v_dot2_f32_bf16 v123, v239, v103, v123
  buffer_load_dwordx4 v[236:239], v4, s[36:39], s77 offen nt
  s_add_u32 s77, s77, 4096
  s_waitcnt vmcnt(31)
  v_dot2_f32_bf16 v124, v240, v100, 0
  v_dot2_f32_bf16 v124, v241, v101, v124
  v_dot2_f32_bf16 v124, v242, v102, v124
  v_dot2_f32_bf16 v124, v243, v103, v124
  buffer_load_dwordx4 v[240:243], v4, s[36:39], s77 offen nt
  s_add_u32 s77, s77, 4096
  s_waitcnt vmcnt(31)
  v_dot2_f32_bf16 v125, v244, v100, 0
  v_dot2_f32_bf16 v125, v245, v101, v125
  v_dot2_f32_bf16 v125, v246, v102, v125
  v_dot2_f32_bf16 v125, v247, v103, v125
  buffer_load_dwordx4 v[244:247], v4, s[36:39], s77 offen nt
  s_add_u32 s77, s77, 4096
  s_waitcnt vmcnt(31)
  v_dot2_f32_bf16 v126, v248, v100, 0
  v_dot2_f32_bf16 v126, v249, v101, v126
  v_dot2_f32_bf16 v126, v250, v102, v126
  v_dot2_f32_bf16 v126, v251, v103, v126
  buffer_load_dwordx4 v[248:251], v4, s[36:39], s77 offen nt
  s_add_u32 s77, s77, 4096
  s_waitcnt vmcnt(31)
  v_dot2_f32_bf16 v127, v252, v100, 0
  v_dot2_f32_bf16 v127, v253, v101, v127
  v_dot2_f32_bf16 v127, v254, v102, v127
  v_dot2_f32_bf16 v127, v255, v103, v127
  buffer_load_dwordx4 v[252:255], v4, s[36:39], s77 offen nt
  s_add_u32 s77, s77, 4096
  s_nop 1
  v_add_f32_dpp v112, v112, v112 row_ror:8 row_mask:0xf bank_mask:0x3
  v_add_f32_dpp v112, v120, v120 row_ror:8 row_mask:0xf bank_mask:0xc
  v_add_f32_dpp v113, v113, v113 row_ror:8 row_mask:0xf bank_mask:0x3
  v_add_f32_dpp v113, v121, v121 row_ror:8 row_mask:0xf bank_mask:0xc
  v_add_f32_dpp v114, v114, v114 row_ror:8 row_mask:0xf bank_mask:0x3
  v_add_f32_dpp v114, v122, v122 row_ror:8 row_mask:0xf bank_mask:0xc
  v_add_f32_dpp v115, v115, v115 row_ror:8 row_mask:0xf bank_mask:0x3
  v_add_f32_dpp v115, v123, v123 row_ror:8 row_mask:0xf bank_mask:0xc
  v_add_f32_dpp v116, v116, v116 row_ror:8 row_mask:0xf bank_mask:0x3
  v_add_f32_dpp v116, v124, v124 row_ror:8 row_mask:0xf bank_mask:0xc
  v_add_f32_dpp v117, v117, v117 row_ror:8 row_mask:0xf bank_mask:0x3
  v_add_f32_dpp v117, v125, v125 row_ror:8 row_mask:0xf bank_mask:0xc
  v_add_f32_dpp v118, v118, v118 row_ror:8 row_mask:0xf bank_mask:0x3
  v_add_f32_dpp v118, v126, v126 row_ror:8 row_mask:0xf bank_mask:0xc
  v_add_f32_dpp v119, v119, v119 row_ror:8 row_mask:0xf bank_mask:0x3
  v_add_f32_dpp v119, v127, v127 row_ror:8 row_mask:0xf bank_mask:0xc
  v_add_f32_dpp v112, v112, v112 row_half_mirror row_mask:0xf bank_mask:0x5
  v_add_f32_dpp v112, v116, v116 row_half_mirror row_mask:0xf bank_mask:0xa
  v_add_f32_dpp v113, v113, v113 row_half_mirror row_mask:0xf bank_mask:0x5
  v_add_f32_dpp v113, v117, v117 row_half_mirror row_mask:0xf bank_mask:0xa
  v_add_f32_dpp v114, v114, v114 row_half_mirror row_mask:0xf bank_mask:0x5
  v_add_f32_dpp v114, v118, v118 row_half_mirror row_mask:0xf bank_mask:0xa
  v_add_f32_dpp v115, v115, v115 row_half_mirror row_mask:0xf bank_mask:0x5
  v_add_f32_dpp v115, v119, v119 row_half_mirror row_mask:0xf bank_mask:0xa
  s_nop 1
  v_add_f32_dpp v112, v112, v112 quad_perm:[2,3,0,1] row_mask:0xf bank_mask:0xf
  v_add_f32_dpp v113, v113, v113 quad_perm:[2,3,0,1] row_mask:0xf bank_mask:0xf
  v_add_f32_dpp v114, v114, v114 quad_perm:[2,3,0,1] row_mask:0xf bank_mask:0xf
  v_add_f32_dpp v115, v115, v115 quad_perm:[2,3,0,1] row_mask:0xf bank_mask:0xf
  v_cndmask_b32 v112, v112, v114, s[84:85]
  v_cndmask_b32 v113, v113, v115, s[84:85]
  s_nop 1
  v_add_f32_dpp v112, v112, v112 quad_perm:[1,0,3,2] row_mask:0xf bank_mask:0xf
  v_add_f32_dpp v113, v113, v113 quad_perm:[1,0,3,2] row_mask:0xf bank_mask:0xf
  v_cndmask_b32 v15, v112, v113, s[86:87]
  s_setpc_b64 s[82:83]
.p2align 6
L_vbody:
  v_and_b32_dpp v84, v14, v96 row_newbcast:0 row_mask:0xf bank_mask:0xf
  v_and_b32_dpp v85, v14, v97 row_newbcast:0 row_mask:0xf bank_mask:0xf
  v_and_b32_dpp v86, v14, v98 row_newbcast:0 row_mask:0xf bank_mask:0xf
  v_and_b32_dpp v87, v14, v99 row_newbcast:0 row_mask:0xf bank_mask:0xf
  s_waitcnt vmcnt(31)
  s_nop 0
  v_mfma_f32_16x16x32_bf16 v[80:83], v[84:87], v[128:131], v[80:83]
  buffer_load_dwordx4 v[128:131], v4, s[36:39], s77 offen nt
  s_add_u32 s77, s77, 4096
  v_and_b32_dpp v84, v14, v96 row_newbcast:1 row_mask:0xf bank_mask:0xf
  v_and_b32_dpp v85, v14, v97 row_newbcast:1 row_mask:0xf bank_mask:0xf
  v_and_b32_dpp v86, v14, v98 row_newbcast:1 row_mask:0xf bank_mask:0xf
  v_and_b32_dpp v87, v14, v99 row_newbcast:1 row_mask:0xf bank_mask:0xf
  s_waitcnt vmcnt(31)
  s_nop 0
  v_mfma_f32_16x16x32_bf16 v[80:83], v[84:87], v[132:135], v[80:83]
  buffer_load_dwordx4 v[132:135], v4, s[36:39], s77 offen nt
  s_add_u32 s77, s77, 4096
  v_and_b32_dpp v84, v14, v96 row_newbcast:2 row_mask:0xf bank_mask:0xf
  v_and_b32_dpp v85, v14, v97 row_newbcast:2 row_mask:0xf bank_mask:0xf
  v_and_b32_dpp v86, v14, v98 row_newbcast:2 row_mask:0xf bank_mask:0xf
  v_and_b32_dpp v87, v14, v99 row_newbcast:2 row_mask:0xf bank_mask:0xf
  s_waitcnt vmcnt(31)
  s_nop 0
  v_mfma_f32_16x16x32_bf16 v[80:83], v[84:87], v[136:139], v[80:83]
  buffer_load_dwordx4 v[136:139], v4, s[36:39], s77 offen nt
  s_add_u32 s77, s77, 4096
  v_and_b32_dpp v84, v14, v96 row_newbcast:3 row_mask:0xf bank_mask:0xf
  v_and_b32_dpp v85, v14, v97 row_newbcast:3 row_mask:0xf bank_mask:0xf
  v_and_b32_dpp v86, v14, v98 row_newbcast:3 row_mask:0xf bank_mask:0xf
  v_and_b32_dpp v87, v14, v99 row_newbcast:3 row_mask:0xf bank_mask:0xf
  s_waitcnt vmcnt(31)
  s_nop 0
  v_mfma_f32_16x16x32_bf16 v[80:83], v[84:87], v[140:143], v[80:83]
  buffer_load_dwordx4 v[140:143], v4, s[36:39], s77 offen nt
  s_add_u32 s77, s77, 4096
  v_and_b32_dpp v84, v14, v96 row_newbcast:4 row_mask:0xf bank_mask:0xf
  v_and_b32_dpp v85, v14, v97 row_newbcast:4 row_mask:0xf bank_mask:0xf
  v_and_b32_dpp v86, v14, v98 row_newbcast:4 row_mask:0xf bank_mask:0xf
  v_and_b32_dpp v87, v14, v99 row_newbcast:4 row_mask:0xf bank_mask:0xf
  s_waitcnt vmcnt(31)
  s_nop 0
  v_mfma_f32_16x16x32_bf16 v[80:83], v[84:87], v[144:147], v[80:83]
  buffer_load_dwordx4 v[144:147], v4, s[36:39], s77 offen nt
  s_add_u32 s77, s77, 4096
  v_and_b32_dpp v84, v14, v96 row_newbcast:5 row_mask:0xf bank_mask:0xf
  v_and_b32_dpp v85, v14, v97 row_newbcast:5 row_mask:0xf bank_mask:0xf
  v_and_b32_dpp v86, v14, v98 row_newbcast:5 row_mask:0xf bank_mask:0xf
  v_and_b32_dpp v87, v14, v99 row_newbcast:5 row_mask:0xf bank_mask:0xf
  s_waitcnt vmcnt(31)
  s_nop 0
  v_mfma_f32_16x16x32_bf16 v[80:83], v[84:87], v[148:151], v[80:83]
  buffer_load_dwordx4 v[148:151], v4, s[36:39], s77 offen nt
  s_add_u32 s77, s77, 4096
  v_and_b32_dpp v84, v14, v96 row_newbcast:6 row_mask:0xf bank_mask:0xf
  v_and_b32_dpp v85, v14, v97 row_newbcast:6 row_mask:0xf bank_mask:0xf
  v_and_b32_dpp v86, v14, v98 row_newbcast:6 row_mask:0xf bank_mask:0xf
  v_and_b32_dpp v87, v14, v99 row_newbcast:6 row_mask:0xf bank_mask:0xf
  s_waitcnt vmcnt(31)
  s_nop 0
  v_mfma_f32_16x16x32_bf16 v[80:83], v[84:87], v[152:155], v[80:83]
  buffer_load_dwordx4 v[152:155], v4, s[36:39], s77 offen nt
  s_add_u32 s77, s77, 4096
  v_and_b32_dpp v84, v14, v96 row_newbcast:7 row_mask:0xf bank_mask:0xf
  v_and_b32_dpp v85, v14, v97 row_newbcast:7 row_mask:0xf bank_mask:0xf
  v_and_b32_dpp v86, v14, v98 row_newbcast:7 row_mask:0xf bank_mask:0xf
  v_and_b32_dpp v87, v14, v99 row_newbcast:7 row_mask:0xf bank_mask:0xf
  s_waitcnt vmcnt(31)
  s_nop 0
  v_mfma_f32_16x16x32_bf16 v[80:83], v[84:87], v[156:159], v[80:83]
  buffer_load_dwordx4 v[156:159], v4, s[36:39], s77 offen nt
  s_add_u32 s77, s77, 4096
  v_and_b32_dpp v84, v14, v96 row_newbcast:8 row_mask:0xf bank_mask:0xf
  v_and_b32_dpp v85, v14, v97 row_newbcast:8 row_mask:0xf bank_mask:0xf
  v_and_b32_dpp v86, v14, v98 row_newbcast:8 row_mask:0xf bank_mask:0xf
  v_and_b32_dpp v87, v14, v99 row_newbcast:8 row_mask:0xf bank_mask:0xf
  s_waitcnt vmcnt(31)
  s_nop 0
  v_mfma_f32_16x16x32_bf16 v[80:83], v[84:87], v[160:163], v[80:83]
  buffer_load_dwordx4 v[160:163], v4, s[36:39], s77 offen nt
  s_add_u32 s77, s77, 4096
  v_and_b32_dpp v84, v14, v96 row_newbcast:9 row_mask:0xf bank_mask:0xf
  v_and_b32_dpp v85, v14, v97 row_newbcast:9 row_mask:0xf bank_mask:0xf
  v_and_b32_dpp v86, v14, v98 row_newbcast:9 row_mask:0xf bank_mask:0xf
  v_and_b32_dpp v87, v14, v99 row_newbcast:9 row_mask:0xf bank_mask:0xf
  s_waitcnt vmcnt(31)
  s_nop 0
  v_mfma_f32_16x16x32_bf16 v[80:83], v[84:87], v[164:167], v[80:83]
  buffer_load_dwordx4 v[164:167], v4, s[36:39], s77 offen nt
  s_add_u32 s77, s77, 4096
  v_and_b32_dpp v84, v14, v96 row_newbcast:10 row_mask:0xf bank_mask:0xf
  v_and_b32_dpp v85, v14, v97 row_newbcast:10 row_mask:0xf bank_mask:0xf
  v_and_b32_dpp v86, v14, v98 row_newbcast:10 row_mask:0xf bank_mask:0xf
  v_and_b32_dpp v87, v14, v99 row_newbcast:10 row_mask:0xf bank_mask:0xf
  s_waitcnt vmcnt(31)
  s_nop 0
  v_mfma_f32_16x16x32_bf16 v[80:83], v[84:87], v[168:171], v[80:83]
  buffer_load_dwordx4 v[168:171], v4, s[36:39], s77 offen nt
  s_add_u32 s77, s77, 4096
  v_and_b32_dpp v84, v14, v96 row_newbcast:11 row_mask:0xf bank_mask:0xf
  v_and_b32_dpp v85, v14, v97 row_newbcast:11 row_mask:0xf bank_mask:0xf
  v_and_b32_dpp v86, v14, v98 row_newbcast:11 row_mask:0xf bank_mask:0xf
  v_and_b32_dpp v87, v14, v99 row_newbcast:11 row_mask:0xf bank_mask:0xf
  s_waitcnt vmcnt(31)
  s_nop 0
  v_mfma_f32_16x16x32_bf16 v[80:83], v[84:87], v[172:175], v[80:83]
  buffer_load_dwordx4 v[172:175], v4, s[36:39], s77 offen nt
  s_add_u32 s77, s77, 4096
  v_and_b32_dpp v84, v14, v96 row_newbcast:12 row_mask:0xf bank_mask:0xf
  v_and_b32_dpp v85, v14, v97 row_newbcast:12 row_mask:0xf bank_mask:0xf
  v_and_b32_dpp v86, v14, v98 row_newbcast:12 row_mask:0xf bank_mask:0xf
  v_and_b32_dpp v87, v14, v99 row_newbcast:12 row_mask:0xf bank_mask:0xf
  s_waitcnt vmcnt(31)
  s_nop 0
  v_mfma_f32_16x16x32_bf16 v[80:83], v[84:87], v[176:179], v[80:83]
  buffer_load_dwordx4 v[176:179], v4, s[36:39], s77 offen nt
  s_add_u32 s77, s77, 4096
  v_and_b32_dpp v84, v14, v96 row_newbcast:13 row_mask:0xf bank_mask:0xf
  v_and_b32_dpp v85, v14, v97 row_newbcast:13 row_mask:0xf bank_mask:0xf
  v_and_b32_dpp v86, v14, v98 row_newbcast:13 row_mask:0xf bank_mask:0xf
  v_and_b32_dpp v87, v14, v99 row_newbcast:13 row_mask:0xf bank_mask:0xf
  s_waitcnt vmcnt(31)
  s_nop 0
  v_mfma_f32_16x16x32_bf16 v[80:83], v[84:87], v[180:183], v[80:83]
  buffer_load_dwordx4 v[180:183], v4, s[36:39], s77 offen nt
  s_add_u32 s77, s77, 4096
  v_and_b32_dpp v84, v14, v96 row_newbcast:14 row_mask:0xf bank_mask:0xf
  v_and_b32_dpp v85, v14, v97 row_newbcast:14 row_mask:0xf bank_mask:0xf
  v_and_b32_dpp v86, v14, v98 row_newbcast:14 row_mask:0xf bank_mask:0xf
  v_and_b32_dpp v87, v14, v99 row_newbcast:14 row_mask:0xf bank_mask:0xf
  s_waitcnt vmcnt(31)
  s_nop 0
  v_mfma_f32_16x16x32_bf16 v[80:83], v[84:87], v[184:187], v[80:83]
  buffer_load_dwordx4 v[184:187], v4, s[36:39], s77 offen nt
  s_add_u32 s77, s77, 4096
  v_and_b32_dpp v84, v14, v96 row_newbcast:15 row_mask:0xf bank_mask:0xf
  v_and_b32_dpp v85, v14, v97 row_newbcast:15 row_mask:0xf bank_mask:0xf
  v_and_b32_dpp v86, v14, v98 row_newbcast:15 row_mask:0xf bank_mask:0xf
  v_and_b32_dpp v87, v14, v99 row_newbcast:15 row_mask:0xf bank_mask:0xf
  s_waitcnt vmcnt(31)
  s_nop 0
  v_mfma_f32_16x16x32_bf16 v[80:83], v[84:87], v[188:191], v[80:83]
  buffer_load_dwordx4 v[188:191], v4, s[36:39], s77 offen nt
  s_add_u32 s77, s77, 4096
  v_and_b32_dpp v84, v15, v96 row_newbcast:0 row_mask:0xf bank_mask:0xf
  v_and_b32_dpp v85, v15, v97 row_newbcast:0 row_mask:0xf bank_mask:0xf
  v_and_b32_dpp v86, v15, v98 row_newbcast:0 row_mask:0xf bank_mask:0xf
  v_and_b32_dpp v87, v15, v99 row_newbcast:0 row_mask:0xf bank_mask:0xf
  s_waitcnt vmcnt(31)
  s_nop 0
  v_mfma_f32_16x16x32_bf16 v[80:83], v[84:87], v[192:195], v[80:83]
  buffer_load_dwordx4 v[192:195], v4, s[36:39], s77 offen nt
  s_add_u32 s77, s77, 4096
  v_and_b32_dpp v84, v15, v96 row_newbcast:1 row_mask:0xf bank_mask:0xf
  v_and_b32_dpp v85, v15, v97 row_newbcast:1 row_mask:0xf bank_mask:0xf
  v_and_b32_dpp v86, v15, v98 row_newbcast:1 row_mask:0xf bank_mask:0xf
  v_and_b32_dpp v87, v15, v99 row_newbcast:1 row_mask:0xf bank_mask:0xf
  s_waitcnt vmcnt(31)
  s_nop 0
  v_mfma_f32_16x16x32_bf16 v[80:83], v[84:87], v[196:199], v[80:83]
  buffer_load_dwordx4 v[196:199], v4, s[36:39], s77 offen nt
  s_add_u32 s77, s77, 4096
  v_and_b32_dpp v84, v15, v96 row_newbcast:2 row_mask:0xf bank_mask:0xf
  v_and_b32_dpp v85, v15, v97 row_newbcast:2 row_mask:0xf bank_mask:0xf
  v_and_b32_dpp v86, v15, v98 row_newbcast:2 row_mask:0xf bank_mask:0xf
  v_and_b32_dpp v87, v15, v99 row_newbcast:2 row_mask:0xf bank_mask:0xf
  s_waitcnt vmcnt(31)
  s_nop 0
  v_mfma_f32_16x16x32_bf16 v[80:83], v[84:87], v[200:203], v[80:83]
  buffer_load_dwordx4 v[200:203], v4, s[36:39], s77 offen nt
  s_add_u32 s77, s77, 4096
  v_and_b32_dpp v84, v15, v96 row_newbcast:3 row_mask:0xf bank_mask:0xf
  v_and_b32_dpp v85, v15, v97 row_newbcast:3 row_mask:0xf bank_mask:0xf
  v_and_b32_dpp v86, v15, v98 row_newbcast:3 row_mask:0xf bank_mask:0xf
  v_and_b32_dpp v87, v15, v99 row_newbcast:3 row_mask:0xf bank_mask:0xf
  s_waitcnt vmcnt(31)
  s_nop 0
  v_mfma_f32_16x16x32_bf16 v[80:83], v[84:87], v[204:207], v[80:83]
  buffer_load_dwordx4 v[204:207], v4, s[36:39], s77 offen nt
  s_add_u32 s77, s77, 4096
  v_and_b32_dpp v84, v15, v96 row_newbcast:4 row_mask:0xf bank_mask:0xf
  v_and_b32_dpp v85, v15, v97 row_newbcast:4 row_mask:0xf bank_mask:0xf
  v_and_b32_dpp v86, v15, v98 row_newbcast:4 row_mask:0xf bank_mask:0xf
  v_and_b32_dpp v87, v15, v99 row_newbcast:4 row_mask:0xf bank_mask:0xf
  s_waitcnt vmcnt(31)
  s_nop 0
  v_mfma_f32_16x16x32_bf16 v[80:83], v[84:87], v[208:211], v[80:83]
  buffer_load_dwordx4 v[208:211], v4, s[36:39], s77 offen nt
  s_add_u32 s77, s77, 4096
  v_and_b32_dpp v84, v15, v96 row_newbcast:5 row_mask:0xf bank_mask:0xf
  v_and_b32_dpp v85, v15, v97 row_newbcast:5 row_mask:0xf bank_mask:0xf
  v_and_b32_dpp v86, v15, v98 row_newbcast:5 row_mask:0xf bank_mask:0xf
  v_and_b32_dpp v87, v15, v99 row_newbcast:5 row_mask:0xf bank_mask:0xf
  s_waitcnt vmcnt(31)
  s_nop 0
  v_mfma_f32_16x16x32_bf16 v[80:83], v[84:87], v[212:215], v[80:83]
  buffer_load_dwordx4 v[212:215], v4, s[36:39], s77 offen nt
  s_add_u32 s77, s77, 4096
  v_and_b32_dpp v84, v15, v96 row_newbcast:6 row_mask:0xf bank_mask:0xf
  v_and_b32_dpp v85, v15, v97 row_newbcast:6 row_mask:0xf bank_mask:0xf
  v_and_b32_dpp v86, v15, v98 row_newbcast:6 row_mask:0xf bank_mask:0xf
  v_and_b32_dpp v87, v15, v99 row_newbcast:6 row_mask:0xf bank_mask:0xf
  s_waitcnt vmcnt(31)
  s_nop 0
  v_mfma_f32_16x16x32_bf16 v[80:83], v[84:87], v[216:219], v[80:83]
  buffer_load_dwordx4 v[216:219], v4, s[36:39], s77 offen nt
  s_add_u32 s77, s77, 4096
  v_and_b32_dpp v84, v15, v96 row_newbcast:7 row_mask:0xf bank_mask:0xf
  v_and_b32_dpp v85, v15, v97 row_newbcast:7 row_mask:0xf bank_mask:0xf
  v_and_b32_dpp v86, v15, v98 row_newbcast:7 row_mask:0xf bank_mask:0xf
  v_and_b32_dpp v87, v15, v99 row_newbcast:7 row_mask:0xf bank_mask:0xf
  s_waitcnt vmcnt(31)
  s_nop 0
  v_mfma_f32_16x16x32_bf16 v[80:83], v[84:87], v[220:223], v[80:83]
  buffer_load_dwordx4 v[220:223], v4, s[36:39], s77 offen nt
  s_add_u32 s77, s77, 4096
  v_and_b32_dpp v84, v15, v96 row_newbcast:8 row_mask:0xf bank_mask:0xf
  v_and_b32_dpp v85, v15, v97 row_newbcast:8 row_mask:0xf bank_mask:0xf
  v_and_b32_dpp v86, v15, v98 row_newbcast:8 row_mask:0xf bank_mask:0xf
  v_and_b32_dpp v87, v15, v99 row_newbcast:8 row_mask:0xf bank_mask:0xf
  s_waitcnt vmcnt(31)
  s_nop 0
  v_mfma_f32_16x16x32_bf16 v[80:83], v[84:87], v[224:227], v[80:83]
  buffer_load_dwordx4 v[224:227], v4, s[36:39], s77 offen nt
  s_add_u32 s77, s77, 4096
  v_and_b32_dpp v84, v15, v96 row_newbcast:9 row_mask:0xf bank_mask:0xf
  v_and_b32_dpp v85, v15, v97 row_newbcast:9 row_mask:0xf bank_mask:0xf
  v_and_b32_dpp v86, v15, v98 row_newbcast:9 row_mask:0xf bank_mask:0xf
  v_and_b32_dpp v87, v15, v99 row_newbcast:9 row_mask:0xf bank_mask:0xf
  s_waitcnt vmcnt(31)
  s_nop 0
  v_mfma_f32_16x16x32_bf16 v[80:83], v[84:87], v[228:231], v[80:83]
  buffer_load_dwordx4 v[228:231], v4, s[36:39], s77 offen nt
  s_add_u32 s77, s77, 4096
  v_and_b32_dpp v84, v15, v96 row_newbcast:10 row_mask:0xf bank_mask:0xf
  v_and_b32_dpp v85, v15, v97 row_newbcast:10 row_mask:0xf bank_mask:0xf
  v_and_b32_dpp v86, v15, v98 row_newbcast:10 row_mask:0xf bank_mask:0xf
  v_and_b32_dpp v87, v15, v99 row_newbcast:10 row_mask:0xf bank_mask:0xf
  s_waitcnt vmcnt(31)
  s_nop 0
  v_mfma_f32_16x16x32_bf16 v[80:83], v[84:87], v[232:235], v[80:83]
  buffer_load_dwordx4 v[232:235], v4, s[36:39], s77 offen nt
  s_add_u32 s77, s77, 4096
  v_and_b32_dpp v84, v15, v96 row_newbcast:11 row_mask:0xf bank_mask:0xf
  v_and_b32_dpp v85, v15, v97 row_newbcast:11 row_mask:0xf bank_mask:0xf
  v_and_b32_dpp v86, v15, v98 row_newbcast:11 row_mask:0xf bank_mask:0xf
  v_and_b32_dpp v87, v15, v99 row_newbcast:11 row_mask:0xf bank_mask:0xf
  s_waitcnt vmcnt(31)
  s_nop 0
  v_mfma_f32_16x16x32_bf16 v[80:83], v[84:87], v[236:239], v[80:83]
  buffer_load_dwordx4 v[236:239], v4, s[36:39], s77 offen nt
  s_add_u32 s77, s77, 4096
  v_and_b32_dpp v84, v15, v96 row_newbcast:12 row_mask:0xf bank_mask:0xf
  v_and_b32_dpp v85, v15, v97 row_newbcast:12 row_mask:0xf bank_mask:0xf
  v_and_b32_dpp v86, v15, v98 row_newbcast:12 row_mask:0xf bank_mask:0xf
  v_and_b32_dpp v87, v15, v99 row_newbcast:12 row_mask:0xf bank_mask:0xf
  s_waitcnt vmcnt(31)
  s_nop 0
  v_mfma_f32_16x16x32_bf16 v[80:83], v[84:87], v[240:243], v[80:83]
  buffer_load_dwordx4 v[240:243], v4, s[36:39], s77 offen nt
  s_add_u32 s77, s77, 4096
  v_and_b32_dpp v84, v15, v96 row_newbcast:13 row_mask:0xf bank_mask:0xf
  v_and_b32_dpp v85, v15, v97 row_newbcast:13 row_mask:0xf bank_mask:0xf
  v_and_b32_dpp v86, v15, v98 row_newbcast:13 row_mask:0xf bank_mask:0xf
  v_and_b32_dpp v87, v15, v99 row_newbcast:13 row_mask:0xf bank_mask:0xf
  s_waitcnt vmcnt(31)
  s_nop 0
  v_mfma_f32_16x16x32_bf16 v[80:83], v[84:87], v[244:247], v[80:83]
  buffer_load_dwordx4 v[244:247], v4, s[36:39], s77 offen nt
  s_add_u32 s77, s77, 4096
  v_and_b32_dpp v84, v15, v96 row_newbcast:14 row_mask:0xf bank_mask:0xf
  v_and_b32_dpp v85, v15, v97 row_newbcast:14 row_mask:0xf bank_mask:0xf
  v_and_b32_dpp v86, v15, v98 row_newbcast:14 row_mask:0xf bank_mask:0xf
  v_and_b32_dpp v87, v15, v99 row_newbcast:14 row_mask:0xf bank_mask:0xf
  s_waitcnt vmcnt(31)
  s_nop 0
  v_mfma_f32_16x16x32_bf16 v[80:83], v[84:87], v[248:251], v[80:83]
  buffer_load_dwordx4 v[248:251], v4, s[36:39], s77 offen nt
  s_add_u32 s77, s77, 4096
  v_and_b32_dpp v84, v15, v96 row_newbcast:15 row_mask:0xf bank_mask:0xf
  v_and_b32_dpp v85, v15, v97 row_newbcast:15 row_mask:0xf bank_mask:0xf
  v_and_b32_dpp v86, v15, v98 row_newbcast:15 row_mask:0xf bank_mask:0xf
  v_and_b32_dpp v87, v15, v99 row_newbcast:15 row_mask:0xf bank_mask:0xf
  s_waitcnt vmcnt(31)
  s_nop 0
  v_mfma_f32_16x16x32_bf16 v[80:83], v[84:87], v[252:255], v[80:83]
  buffer_load_dwordx4 v[252:255], v4, s[36:39], s77 offen nt
  s_add_u32 s77, s77, 4096
  s_setpc_b64 s[82:83]
.p2align 6
L_vdrain:
  v_and_b32_dpp v84, v14, v96 row_newbcast:0 row_mask:0xf bank_mask:0xf
  v_and_b32_dpp v85, v14, v97 row_newbcast:0 row_mask:0xf bank_mask:0xf
  v_and_b32_dpp v86, v14, v98 row_newbcast:0 row_mask:0xf bank_mask:0xf
  v_and_b32_dpp v87, v14, v99 row_newbcast:0 row_mask:0xf bank_mask:0xf
  s_waitcnt vmcnt(31)
  s_nop 0
  v_mfma_f32_16x16x32_bf16 v[80:83], v[84:87], v[128:131], v[80:83]
  v_and_b32_dpp v84, v14, v96 row_newbcast:1 row_mask:0xf bank_mask:0xf
  v_and_b32_dpp v85, v14, v97 row_newbcast:1 row_mask:0xf bank_mask:0xf
  v_and_b32_dpp v86, v14, v98 row_newbcast:1 row_mask:0xf bank_mask:0xf
  v_and_b32_dpp v87, v14, v99 row_newbcast:1 row_mask:0xf bank_mask:0xf
  s_waitcnt vmcnt(30)
  s_nop 0
  v_mfma_f32_16x16x32_bf16 v[80:83], v[84:87], v[132:135], v[80:83]
  v_and_b32_dpp v84, v14, v96 row_newbcast:2 row_mask:0xf bank_mask:0xf
  v_and_b32_dpp v85, v14, v97 row_newbcast:2 row_mask:0xf bank_mask:0xf
  v_and_b32_dpp v86, v14, v98 row_newbcast:2 row_mask:0xf bank_mask:0xf
  v_and_b32_dpp v87, v14, v99 row_newbcast:2 row_mask:0xf bank_mask:0xf
  s_waitcnt vmcnt(29)
  s_nop 0
  v_mfma_f32_16x16x32_bf16 v[80:83], v[84:87], v[136:139], v[80:83]
  v_and_b32_dpp v84, v14, v96 row_newbcast:3 row_mask:0xf bank_mask:0xf
  v_and_b32_dpp v85, v14, v97 row_newbcast:3 row_mask:0xf bank_mask:0xf
  v_and_b32_dpp v86, v14, v98 row_newbcast:3 row_mask:0xf bank_mask:0xf
  v_and_b32_dpp v87, v14, v99 row_newbcast:3 row_mask:0xf bank_mask:0xf
  s_waitcnt vmcnt(28)
  s_nop 0
  v_mfma_f32_16x16x32_bf16 v[80:83], v[84:87], v[140:143], v[80:83]
  v_and_b32_dpp v84, v14, v96 row_newbcast:4 row_mask:0xf bank_mask:0xf
  v_and_b32_dpp v85, v14, v97 row_newbcast:4 row_mask:0xf bank_mask:0xf
  v_and_b32_dpp v86, v14, v98 row_newbcast:4 row_mask:0xf bank_mask:0xf
  v_and_b32_dpp v87, v14, v99 row_newbcast:4 row_mask:0xf bank_mask:0xf
  s_waitcnt vmcnt(27)
  s_nop 0
  v_mfma_f32_16x16x32_bf16 v[80:83], v[84:87], v[144:147], v[80:83]
  v_and_b32_dpp v84, v14, v96 row_newbcast:5 row_mask:0xf bank_mask:0xf
  v_and_b32_dpp v85, v14, v97 row_newbcast:5 row_mask:0xf bank_mask:0xf
  v_and_b32_dpp v86, v14, v98 row_newbcast:5 row_mask:0xf bank_mask:0xf
  v_and_b32_dpp v87, v14, v99 row_newbcast:5 row_mask:0xf bank_mask:0xf
  s_waitcnt vmcnt(26)
  s_nop 0
  v_mfma_f32_16x16x32_bf16 v[80:83], v[84:87], v[148:151], v[80:83]
  v_and_b32_dpp v84, v14, v96 row_newbcast:6 row_mask:0xf bank_mask:0xf
  v_and_b32_dpp v85, v14, v97 row_newbcast:6 row_mask:0xf bank_mask:0xf
  v_and_b32_dpp v86, v14, v98 row_newbcast:6 row_mask:0xf bank_mask:0xf
  v_and_b32_dpp v87, v14, v99 row_newbcast:6 row_mask:0xf bank_mask:0xf
  s_waitcnt vmcnt(25)
  s_nop 0
  v_mfma_f32_16x16x32_bf16 v[80:83], v[84:87], v[152:155], v[80:83]
  v_and_b32_dpp v84, v14, v96 row_newbcast:7 row_mask:0xf bank_mask:0xf
  v_and_b32_dpp v85, v14, v97 row_newbcast:7 row_mask:0xf bank_mask:0xf
  v_and_b32_dpp v86, v14, v98 row_newbcast:7 row_mask:0xf bank_mask:0xf
  v_and_b32_dpp v87, v14, v99 row_newbcast:7 row_mask:0xf bank_mask:0xf
  s_waitcnt vmcnt(24)
  s_nop 0
  v_mfma_f32_16x16x32_bf16 v[80:83], v[84:87], v[156:159], v[80:83]
  v_and_b32_dpp v84, v14, v96 row_newbcast:8 row_mask:0xf bank_mask:0xf
  v_and_b32_dpp v85, v14, v97 row_newbcast:8 row_mask:0xf bank_mask:0xf
  v_and_b32_dpp v86, v14, v98 row_newbcast:8 row_mask:0xf bank_mask:0xf
  v_and_b32_dpp v87, v14, v99 row_newbcast:8 row_mask:0xf bank_mask:0xf
  s_waitcnt vmcnt(23)
  s_nop 0
  v_mfma_f32_16x16x32_bf16 v[80:83], v[84:87], v[160:163], v[80:83]
  v_and_b32_dpp v84, v14, v96 row_newbcast:9 row_mask:0xf bank_mask:0xf
  v_and_b32_dpp v85, v14, v97 row_newbcast:9 row_mask:0xf bank_mask:0xf
  v_and_b32_dpp v86, v14, v98 row_newbcast:9 row_mask:0xf bank_mask:0xf
  v_and_b32_dpp v87, v14, v99 row_newbcast:9 row_mask:0xf bank_mask:0xf
  s_waitcnt vmcnt(22)
  s_nop 0
  v_mfma_f32_16x16x32_bf16 v[80:83], v[84:87], v[164:167], v[80:83]
  v_and_b32_dpp v84, v14, v96 row_newbcast:10 row_mask:0xf bank_mask:0xf
  v_and_b32_dpp v85, v14, v97 row_newbcast:10 row_mask:0xf bank_mask:0xf
  v_and_b32_dpp v86, v14, v98 row_newbcast:10 row_mask:0xf bank_mask:0xf
  v_and_b32_dpp v87, v14, v99 row_newbcast:10 row_mask:0xf bank_mask:0xf
  s_waitcnt vmcnt(21)
  s_nop 0
  v_mfma_f32_16x16x32_bf16 v[80:83], v[84:87], v[168:171], v[80:83]
  v_and_b32_dpp v84, v14, v96 row_newbcast:11 row_mask:0xf bank_mask:0xf
  v_and_b32_dpp v85, v14, v97 row_newbcast:11 row_mask:0xf bank_mask:0xf
  v_and_b32_dpp v86, v14, v98 row_newbcast:11 row_mask:0xf bank_mask:0xf
  v_and_b32_dpp v87, v14, v99 row_newbcast:11 row_mask:0xf bank_mask:0xf
  s_waitcnt vmcnt(20)
  s_nop 0
  v_mfma_f32_16x16x32_bf16 v[80:83], v[84:87], v[172:175], v[80:83]
  v_and_b32_dpp v84, v14, v96 row_newbcast:12 row_mask:0xf bank_mask:0xf
  v_and_b32_dpp v85, v14, v97 row_newbcast:12 row_mask:0xf bank_mask:0xf
  v_and_b32_dpp v86, v14, v98 row_newbcast:12 row_mask:0xf bank_mask:0xf
  v_and_b32_dpp v87, v14, v99 row_newbcast:12 row_mask:0xf bank_mask:0xf
  s_waitcnt vmcnt(19)
  s_nop 0
  v_mfma_f32_16x16x32_bf16 v[80:83], v[84:87], v[176:179], v[80:83]
  v_and_b32_dpp v84, v14, v96 row_newbcast:13 row_mask:0xf bank_mask:0xf
  v_and_b32_dpp v85, v14, v97 row_newbcast:13 row_mask:0xf bank_mask:0xf
  v_and_b32_dpp v86, v14, v98 row_newbcast:13 row_mask:0xf bank_mask:0xf
  v_and_b32_dpp v87, v14, v99 row_newbcast:13 row_mask:0xf bank_mask:0xf
  s_waitcnt vmcnt(18)
  s_nop 0
  v_mfma_f32_16x16x32_bf16 v[80:83], v[84:87], v[180:183], v[80:83]
  v_and_b32_dpp v84, v14, v96 row_newbcast:14 row_mask:0xf bank_mask:0xf
  v_and_b32_dpp v85, v14, v97 row_newbcast:14 row_mask:0xf bank_mask:0xf
  v_and_b32_dpp v86, v14, v98 row_newbcast:14 row_mask:0xf bank_mask:0xf
  v_and_b32_dpp v87, v14, v99 row_newbcast:14 row_mask:0xf bank_mask:0xf
  s_waitcnt vmcnt(17)
  s_nop 0
  v_mfma_f32_16x16x32_bf16 v[80:83], v[84:87], v[184:187], v[80:83]
  v_and_b32_dpp v84, v14, v96 row_newbcast:15 row_mask:0xf bank_mask:0xf
  v_and_b32_dpp v85, v14, v97 row_newbcast:15 row_mask:0xf bank_mask:0xf
  v_and_b32_dpp v86, v14, v98 row_newbcast:15 row_mask:0xf bank_mask:0xf
  v_and_b32_dpp v87, v14, v99 row_newbcast:15 row_mask:0xf bank_mask:0xf
  s_waitcnt vmcnt(16)
  s_nop 0
  v_mfma_f32_16x16x32_bf16 v[80:83], v[84:87], v[188:191], v[80:83]
  v_and_b32_dpp v84, v15, v96 row_newbcast:0 row_mask:0xf bank_mask:0xf
  v_and_b32_dpp v85, v15, v97 row_newbcast:0 row_mask:0xf bank_mask:0xf
  v_and_b32_dpp v86, v15, v98 row_newbcast:0 row_mask:0xf bank_mask:0xf
  v_and_b32_dpp v87, v15, v99 row_newbcast:0 row_mask:0xf bank_mask:0xf
  s_waitcnt vmcnt(15)
  s_nop 0
  v_mfma_f32_16x16x32_bf16 v[80:83], v[84:87], v[192:195], v[80:83]
  v_and_b32_dpp v84, v15, v96 row_newbcast:1 row_mask:0xf bank_mask:0xf
  v_and_b32_dpp v85, v15, v97 row_newbcast:1 row_mask:0xf bank_mask:0xf
  v_and_b32_dpp v86, v15, v98 row_newbcast:1 row_mask:0xf bank_mask:0xf
  v_and_b32_dpp v87, v15, v99 row_newbcast:1 row_mask:0xf bank_mask:0xf
  s_waitcnt vmcnt(14)
  s_nop 0
  v_mfma_f32_16x16x32_bf16 v[80:83], v[84:87], v[196:199], v[80:83]
  v_and_b32_dpp v84, v15, v96 row_newbcast:2 row_mask:0xf bank_mask:0xf
  v_and_b32_dpp v85, v15, v97 row_newbcast:2 row_mask:0xf bank_mask:0xf
  v_and_b32_dpp v86, v15, v98 row_newbcast:2 row_mask:0xf bank_mask:0xf
  v_and_b32_dpp v87, v15, v99 row_newbcast:2 row_mask:0xf bank_mask:0xf
  s_waitcnt vmcnt(13)
  s_nop 0
  v_mfma_f32_16x16x32_bf16 v[80:83], v[84:87], v[200:203], v[80:83]
  v_and_b32_dpp v84, v15, v96 row_newbcast:3 row_mask:0xf bank_mask:0xf
  v_and_b32_dpp v85, v15, v97 row_newbcast:3 row_mask:0xf bank_mask:0xf
  v_and_b32_dpp v86, v15, v98 row_newbcast:3 row_mask:0xf bank_mask:0xf
  v_and_b32_dpp v87, v15, v99 row_newbcast:3 row_mask:0xf bank_mask:0xf
  s_waitcnt vmcnt(12)
  s_nop 0
  v_mfma_f32_16x16x32_bf16 v[80:83], v[84:87], v[204:207], v[80:83]
  v_and_b32_dpp v84, v15, v96 row_newbcast:4 row_mask:0xf bank_mask:0xf
  v_and_b32_dpp v85, v15, v97 row_newbcast:4 row_mask:0xf bank_mask:0xf
  v_and_b32_dpp v86, v15, v98 row_newbcast:4 row_mask:0xf bank_mask:0xf
  v_and_b32_dpp v87, v15, v99 row_newbcast:4 row_mask:0xf bank_mask:0xf
  s_waitcnt vmcnt(11)
  s_nop 0
  v_mfma_f32_16x16x32_bf16 v[80:83], v[84:87], v[208:211], v[80:83]
  v_and_b32_dpp v84, v15, v96 row_newbcast:5 row_mask:0xf bank_mask:0xf
  v_and_b32_dpp v85, v15, v97 row_newbcast:5 row_mask:0xf bank_mask:0xf
  v_and_b32_dpp v86, v15, v98 row_newbcast:5 row_mask:0xf bank_mask:0xf
  v_and_b32_dpp v87, v15, v99 row_newbcast:5 row_mask:0xf bank_mask:0xf
  s_waitcnt vmcnt(10)
  s_nop 0
  v_mfma_f32_16x16x32_bf16 v[80:83], v[84:87], v[212:215], v[80:83]
  v_and_b32_dpp v84, v15, v96 row_newbcast:6 row_mask:0xf bank_mask:0xf
  v_and_b32_dpp v85, v15, v97 row_newbcast:6 row_mask:0xf bank_mask:0xf
  v_and_b32_dpp v86, v15, v98 row_newbcast:6 row_mask:0xf bank_mask:0xf
  v_and_b32_dpp v87, v15, v99 row_newbcast:6 row_mask:0xf bank_mask:0xf
  s_waitcnt vmcnt(9)
  s_nop 0
  v_mfma_f32_16x16x32_bf16 v[80:83], v[84:87], v[216:219], v[80:83]
  v_and_b32_dpp v84, v15, v96 row_newbcast:7 row_mask:0xf bank_mask:0xf
  v_and_b32_dpp v85, v15, v97 row_newbcast:7 row_mask:0xf bank_mask:0xf
  v_and_b32_dpp v86, v15, v98 row_newbcast:7 row_mask:0xf bank_mask:0xf
  v_and_b32_dpp v87, v15, v99 row_newbcast:7 row_mask:0xf bank_mask:0xf
  s_waitcnt vmcnt(8)
  s_nop 0
  v_mfma_f32_16x16x32_bf16 v[80:83], v[84:87], v[220:223], v[80:83]
  v_and_b32_dpp v84, v15, v96 row_newbcast:8 row_mask:0xf bank_mask:0xf
  v_and_b32_dpp v85, v15, v97 row_newbcast:8 row_mask:0xf bank_mask:0xf
  v_and_b32_dpp v86, v15, v98 row_newbcast:8 row_mask:0xf bank_mask:0xf
  v_and_b32_dpp v87, v15, v99 row_newbcast:8 row_mask:0xf bank_mask:0xf
  s_waitcnt vmcnt(7)
  s_nop 0
  v_mfma_f32_16x16x32_bf16 v[80:83], v[84:87], v[224:227], v[80:83]
  v_and_b32_dpp v84, v15, v96 row_newbcast:9 row_mask:0xf bank_mask:0xf
  v_and_b32_dpp v85, v15, v97 row_newbcast:9 row_mask:0xf bank_mask:0xf
  v_and_b32_dpp v86, v15, v98 row_newbcast:9 row_mask:0xf bank_mask:0xf
  v_and_b32_dpp v87, v15, v99 row_newbcast:9 row_mask:0xf bank_mask:0xf
  s_waitcnt vmcnt(6)
  s_nop 0
  v_mfma_f32_16x16x32_bf16 v[80:83], v[84:87], v[228:231], v[80:83]
  v_and_b32_dpp v84, v15, v96 row_newbcast:10 row_mask:0xf bank_mask:0xf
  v_and_b32_dpp v85, v15, v97 row_newbcast:10 row_mask:0xf bank_mask:0xf
  v_and_b32_dpp v86, v15, v98 row_newbcast:10 row_mask:0xf bank_mask:0xf
  v_and_b32_dpp v87, v15, v99 row_newbcast:10 row_mask:0xf bank_mask:0xf
  s_waitcnt vmcnt(5)
  s_nop 0
  v_mfma_f32_16x16x32_bf16 v[80:83], v[84:87], v[232:235], v[80:83]
  v_and_b32_dpp v84, v15, v96 row_newbcast:11 row_mask:0xf bank_mask:0xf
  v_and_b32_dpp v85, v15, v97 row_newbcast:11 row_mask:0xf bank_mask:0xf
  v_and_b32_dpp v86, v15, v98 row_newbcast:11 row_mask:0xf bank_mask:0xf
  v_and_b32_dpp v87, v15, v99 row_newbcast:11 row_mask:0xf bank_mask:0xf
  s_waitcnt vmcnt(4)
  s_nop 0
  v_mfma_f32_16x16x32_bf16 v[80:83], v[84:87], v[236:239], v[80:83]
  v_and_b32_dpp v84, v15, v96 row_newbcast:12 row_mask:0xf bank_mask:0xf
  v_and_b32_dpp v85, v15, v97 row_newbcast:12 row_mask:0xf bank_mask:0xf
  v_and_b32_dpp v86, v15, v98 row_newbcast:12 row_mask:0xf bank_mask:0xf
  v_and_b32_dpp v87, v15, v99 row_newbcast:12 row_mask:0xf bank_mask:0xf
  s_waitcnt vmcnt(3)
  s_nop 0
  v_mfma_f32_16x16x32_bf16 v[80:83], v[84:87], v[240:243], v[80:83]
  v_and_b32_dpp v84, v15, v96 row_newbcast:13 row_mask:0xf bank_mask:0xf
  v_and_b32_dpp v85, v15, v97 row_newbcast:13 row_mask:0xf bank_mask:0xf
  v_and_b32_dpp v86, v15, v98 row_newbcast:13 row_mask:0xf bank_mask:0xf
  v_and_b32_dpp v87, v15, v99 row_newbcast:13 row_mask:0xf bank_mask:0xf
  s_waitcnt vmcnt(2)
  s_nop 0
  v_mfma_f32_16x16x32_bf16 v[80:83], v[84:87], v[244:247], v[80:83]
  v_and_b32_dpp v84, v15, v96 row_newbcast:14 row_mask:0xf bank_mask:0xf
  v_and_b32_dpp v85, v15, v97 row_newbcast:14 row_mask:0xf bank_mask:0xf
  v_and_b32_dpp v86, v15, v98 row_newbcast:14 row_mask:0xf bank_mask:0xf
  v_and_b32_dpp v87, v15, v99 row_newbcast:14 row_mask:0xf bank_mask:0xf
  s_waitcnt vmcnt(1)
  s_nop 0
  v_mfma_f32_16x16x32_bf16 v[80:83], v[84:87], v[248:251], v[80:83]
  v_and_b32_dpp v84, v15, v96 row_newbcast:15 row_mask:0xf bank_mask:0xf
  v_and_b32_dpp v85, v15, v97 row_newbcast:15 row_mask:0xf bank_mask:0xf
  v_and_b32_dpp v86, v15, v98 row_newbcast:15 row_mask:0xf bank_mask:0xf
  v_and_b32_dpp v87, v15, v99 row_newbcast:15 row_mask:0xf bank_mask:0xf
  s_waitcnt vmcnt(0)
  s_nop 0
  v_mfma_f32_16x16x32_bf16 v[80:83], v[84:87], v[252:255], v[80:83]
  s_setpc_b64 s[82:83]
.section .rodata,"a"
.p2align 6
.amdhsa_kernel parallel_sum__gqa_block_cached__geglu_ffn__decode_kernel
  .amdhsa_next_free_vgpr 512
  .amdhsa_next_free_sgpr 100
  .amdhsa_accum_offset 256
  .amdhsa_group_segment_fixed_size 0
  .amdhsa_kernarg_size 96
  .amdhsa_user_sgpr_count 2
  .amdhsa_user_sgpr_kernarg_segment_ptr 1
  .amdhsa_system_sgpr_workgroup_id_x 1
  .amdhsa_float_denorm_mode_32 3
  .amdhsa_float_denorm_mode_16_64 3
.end_amdhsa_kernel
```
